```python
import torch

def _softmax(x, axis=-1):
    return torch.softmax(x, dim=axis)
def _gelu(x):
    return torch.nn.functional.gelu(x, approximate="tanh")
def _silu(x):
    return torch.nn.functional.silu(x)
def _sigmoid(x):
    return torch.sigmoid(x)
def _layernorm(x, axis=-1, eps=1e-5):
    m = x.mean(dim=axis, keepdim=True)
    v = x.var(dim=axis, keepdim=True, unbiased=False)
    return (x - m) / torch.sqrt(v + eps)
def _scatter_add(tgt, idx, src, axis=0):
    return tgt.clone().index_add_(axis, idx, src)
def _segment_sum(src, seg, n):
    out = torch.zeros((n,) + src.shape[1:], dtype=src.dtype)
    return out.index_add_(0, seg, src)
def _pad(x, pw):
    flat = tuple(v for pair in reversed(pw) for v in pair)
    return torch.nn.functional.pad(x, flat)

kernel_name = 'concat_heads__gqa_block_cached__mha_block_cached__near_ridge'

def setup_inputs():

    _w = (lambda a: (lambda t: t.to(torch.bfloat16) if t.is_floating_point() else t)(torch.as_tensor(a)))
    def _A_setup():
        B, Sq, D = 8, 64, 576
        Hq, Hkv, Sk, Dh = 32, 16, 512, 128
        assert Hq % Hkv == 0, (Hq, Hkv)
        return {
            "x": _w((lambda *s: torch.randn(*s, dtype=torch.bfloat16) * 0.8)(B, Sq, D)),
            "k_cache": _w((lambda *s: torch.randn(*s, dtype=torch.bfloat16) * 0.8)(B, Hkv, Sk, Dh)),
            "v_cache": _w((lambda *s: torch.randn(*s, dtype=torch.bfloat16) * 0.05)(B, Hkv, Sk, Dh)),
            "wq": _w((lambda *s: torch.randn(*s, dtype=torch.bfloat16) * 0.8)(D, Hq * Dh) * (D ** -0.5)),
            "wo": _w((lambda *s: torch.randn(*s, dtype=torch.bfloat16) * 0.05)(Hq * Dh, D) * ((Hq * Dh) ** -0.5)),
        }
    _A_in = _A_setup()

    def _B_setup():
        B, Sq, D = 8, 64, 576
        H, Sk, Dh = 32, 512, 128
        return {
            "x": _w((lambda *s: torch.randn(*s, dtype=torch.bfloat16) * 0.8)(B, Sq, D)),
            "k_cache": _w((lambda *s: torch.randn(*s, dtype=torch.bfloat16) * 0.8)(B, H, Sk, Dh)),
            "v_cache": _w((lambda *s: torch.randn(*s, dtype=torch.bfloat16) * 0.05)(B, H, Sk, Dh)),
            "wq": _w((lambda *s: torch.randn(*s, dtype=torch.bfloat16) * 0.8)(D, H * Dh) * (D ** -0.5)),
            "wo": _w((lambda *s: torch.randn(*s, dtype=torch.bfloat16) * 0.05)(H * Dh, D) * ((H * Dh) ** -0.5)),
        }
    _B_in = _B_setup()

    return {
        "A_x": _A_in["x"],
        "A_k_cache": _A_in["k_cache"],
        "A_v_cache": _A_in["v_cache"],
        "A_wq": _A_in["wq"],
        "A_wo": _A_in["wo"],
        "B_x": _B_in["x"],
        "B_k_cache": _B_in["k_cache"],
        "B_v_cache": _B_in["v_cache"],
        "B_wq": _B_in["wq"],
        "B_wo": _B_in["wo"],
    }

def reference(A_x, A_k_cache, A_v_cache, A_wq, A_wo, B_x, B_k_cache, B_v_cache, B_wq, B_wo):
    def _A_ref(x, k_cache, v_cache, wq, wo):
        B, Sq, D = x.shape
        Hq, Dh = 32, 128
        Hkv = k_cache.shape[1]
        rep = Hq // Hkv
        q = (lambda x, *d: x.permute(*d))((x @ wq).reshape(B, Sq, Hq, Dh), 0, 2, 1, 3)
        k = (lambda x, n, axis: torch.repeat_interleave(x, n, dim=axis))(k_cache, rep, axis=1)
        v = (lambda x, n, axis: torch.repeat_interleave(x, n, dim=axis))(v_cache, rep, axis=1)
        scores = torch.einsum("bhqd,bhkd->bhqk", q, k) * (Dh ** -0.5)
        p = _softmax(scores, axis=-1)
        o = torch.einsum("bhqk,bhkd->bhqd", p, v)
        return (lambda x, *d: x.permute(*d))(o, 0, 2, 1, 3).reshape(B, Sq, Hq * Dh) @ wo

    def _B_ref(x, k_cache, v_cache, wq, wo):
        B, Sq, D = x.shape
        H, Dh = 32, 128
        q = (lambda x, *d: x.permute(*d))((x @ wq).reshape(B, Sq, H, Dh), 0, 2, 1, 3)
        scores = torch.einsum("bhqd,bhkd->bhqk", q, k_cache) * (Dh ** -0.5)
        p = _softmax(scores, axis=-1)
        o = torch.einsum("bhqk,bhkd->bhqd", p, v_cache)
        return (lambda x, *d: x.permute(*d))(o, 0, 2, 1, 3).reshape(B, Sq, H * Dh) @ wo

    a = _A_ref(A_x, A_k_cache, A_v_cache, A_wq, A_wo)
    b = _B_ref(B_x, B_k_cache, B_v_cache, B_wq, B_wo)
    return torch.concatenate([a, b], axis=-1)
```

```asm
; @launch grid=(256,1,1) block=(512,1,1) lds=163840
.amdgcn_target "amdgcn-amd-amdhsa--gfx950"
.text
.globl concat_heads__gqa_block_cached__mha_block_cached__near_ridge_kernel
.p2align 8
.type concat_heads__gqa_block_cached__mha_block_cached__near_ridge_kernel,@function
concat_heads__gqa_block_cached__mha_block_cached__near_ridge_kernel:
    s_cmp_ge_u32 s2, 256
    s_cbranch_scc1 L_end
    s_lshr_b32 s4, s2, 3
    s_lshr_b32 s5, s4, 4
    s_xor_b32 s5, s5, 1
    s_mul_i32 s38, s5, 40
    s_add_u32 s46, s0, s38
    s_addc_u32 s47, s1, 0
    s_load_dwordx8 s[48:55], s[46:47], 0
    s_load_dwordx2 s[56:57], s[46:47], 32
    s_load_dwordx4 s[40:43], s[0:1], 80
    s_load_dwordx2 s[44:45], s[0:1], 96
    v_lshrrev_b32 v1, 6, v0
    s_and_b32 s3, s2, 7
    s_and_b32 s6, s4, 1
    v_readfirstlane_b32 s36, v1
    s_lshl_b32 s3, s3, 1
    s_add_u32 s6, s6, s3
    s_lshr_b32 s7, s4, 1
    s_and_b32 s7, s7, 7
    v_and_b32 v1, 63, v0
    s_cmp_lt_u32 s36, 4
    s_cbranch_scc1 L_compute
    s_sub_u32 s37, s36, 4
    v_lshrrev_b32 v20, 5, v1
    v_and_b32 v21, 31, v1
    v_lshrrev_b32 v22, 3, v1
    v_lshrrev_b32 v23, 4, v1
    v_and_b32 v24, 7, v1
    v_and_b32 v25, 15, v1
    s_lshl_b32 s76, s37, 12
    s_cmp_eq_u32 s5, 0
    s_cbranch_scc1 L_ldA
    s_lshl_b32 s77, s37, 16
    s_lshl_b32 s78, s37, 11
    s_add_u32 s78, s78, 32768
    s_mul_i32 s79, s37, 18432
    v_add_u32 v26, 0, v20
    v_lshlrev_b32 v27, 2, v26
    v_xor_b32 v27, v27, v21
    v_lshlrev_b32 v27, 4, v27
    v_lshl_add_u32 v4, v26, 13, v27
    v_add_u32 v26, 2, v20
    v_lshlrev_b32 v27, 2, v26
    v_xor_b32 v27, v27, v21
    v_lshlrev_b32 v27, 4, v27
    v_lshl_add_u32 v5, v26, 13, v27
    v_subrev_u32 v5, 1024, v5
    v_add_u32 v6, 30720, v4
    v_add_u32 v7, 30720, v5
    v_xor_b32 v27, v23, v24
    v_lshlrev_b32 v27, 4, v27
    v_mul_u32_u24 v26, 1152, v22
    v_add_u32 v8, v26, v27
    v_xor_b32 v27, 64, v27
    v_add_u32 v26, 8192, v26
    v_add_u32 v9, v26, v27
    s_waitcnt lgkmcnt(0)
    s_lshl_b32 s38, s6, 9
    s_add_u32 s12, s54, s38
    s_addc_u32 s13, s55, 0
    s_mov_b32 s14, 4710912
    s_mov_b32 s15, 0x20000
    s_mul_i32 s38, s7, 73728
    s_add_u32 s8, s48, s38
    s_addc_u32 s9, s49, 0
    s_mov_b32 s10, 73728
    s_mov_b32 s11, 0x20000
    s_add_u32 m0, s76, 122880
    s_mov_b32 s74, s7
    s_lshl_b32 s58, s74, 19
    s_add_u32 s58, s58, s77
    buffer_load_dwordx4 v4, s[12:15], s58 offen offset:0 lds
    buffer_load_dwordx4 v5, s[12:15], s58 offen offset:1024 lds
    buffer_load_dwordx4 v6, s[12:15], s58 offen offset:2048 lds
    buffer_load_dwordx4 v7, s[12:15], s58 offen offset:3072 lds
    s_add_u32 m0, s76, 139264
    s_mov_b32 s74, s7
    s_lshl_b32 s58, s74, 19
    s_add_u32 s58, s58, s77
    s_add_u32 s58, s58, 262144
    buffer_load_dwordx4 v4, s[12:15], s58 offen offset:0 lds
    buffer_load_dwordx4 v5, s[12:15], s58 offen offset:1024 lds
    buffer_load_dwordx4 v6, s[12:15], s58 offen offset:2048 lds
    buffer_load_dwordx4 v7, s[12:15], s58 offen offset:3072 lds
    s_add_u32 m0, s78, 122880
    s_mov_b32 s74, s7
    s_lshl_b32 s58, s74, 7
    s_add_u32 s58, s58, s79
    buffer_load_dwordx4 v8, s[8:11], s58 offen offset:0 lds
    buffer_load_dwordx4 v9, s[8:11], s58 offen offset:1024 lds
    s_getpc_b64 s[58:59]
L_pcB:
    s_lshr_b32 s38, s2, 3
    s_lshl_b32 s38, s38, 2
    s_add_u32 s38, s38, s37
    s_lshl_b32 s38, s38, 9
    s_min_u32 s38, s38, L_codeend-concat_heads__gqa_block_cached__mha_block_cached__near_ridge_kernel-512
    s_sub_u32 s58, s58, L_pcB-concat_heads__gqa_block_cached__mha_block_cached__near_ridge_kernel
    s_subb_u32 s59, s59, 0
    v_lshlrev_b32 v26, 3, v1
    v_add_u32 v26, s38, v26
    global_load_dwordx2 v[30:31], v26, s[58:59]
    s_add_u32 m0, s76, 0
    s_add_u32 s74, s7, 1
    s_lshl_b32 s58, s74, 19
    s_add_u32 s58, s58, s77
    buffer_load_dwordx4 v4, s[12:15], s58 offen offset:0 lds
    buffer_load_dwordx4 v5, s[12:15], s58 offen offset:1024 lds
    buffer_load_dwordx4 v6, s[12:15], s58 offen offset:2048 lds
    buffer_load_dwordx4 v7, s[12:15], s58 offen offset:3072 lds
    s_add_u32 m0, s76, 16384
    s_add_u32 s74, s7, 1
    s_lshl_b32 s58, s74, 19
    s_add_u32 s58, s58, s77
    s_add_u32 s58, s58, 262144
    buffer_load_dwordx4 v4, s[12:15], s58 offen offset:0 lds
    buffer_load_dwordx4 v5, s[12:15], s58 offen offset:1024 lds
    buffer_load_dwordx4 v6, s[12:15], s58 offen offset:2048 lds
    buffer_load_dwordx4 v7, s[12:15], s58 offen offset:3072 lds
    s_add_u32 m0, s78, 0
    s_add_u32 s74, s7, 1
    s_lshl_b32 s58, s74, 7
    s_add_u32 s58, s58, s79
    buffer_load_dwordx4 v8, s[8:11], s58 offen offset:0 lds
    buffer_load_dwordx4 v9, s[8:11], s58 offen offset:1024 lds
    s_add_u32 m0, s76, 40960
    s_add_u32 s74, s7, 2
    s_sub_u32 s59, s74, 9
    s_cselect_b32 s74, s74, s59
    s_lshl_b32 s58, s74, 19
    s_add_u32 s58, s58, s77
    buffer_load_dwordx4 v4, s[12:15], s58 offen offset:0 lds
    buffer_load_dwordx4 v5, s[12:15], s58 offen offset:1024 lds
    buffer_load_dwordx4 v6, s[12:15], s58 offen offset:2048 lds
    buffer_load_dwordx4 v7, s[12:15], s58 offen offset:3072 lds
    s_add_u32 m0, s76, 57344
    s_add_u32 s74, s7, 2
    s_sub_u32 s59, s74, 9
    s_cselect_b32 s74, s74, s59
    s_lshl_b32 s58, s74, 19
    s_add_u32 s58, s58, s77
    s_add_u32 s58, s58, 262144
    buffer_load_dwordx4 v4, s[12:15], s58 offen offset:0 lds
    buffer_load_dwordx4 v5, s[12:15], s58 offen offset:1024 lds
    buffer_load_dwordx4 v6, s[12:15], s58 offen offset:2048 lds
    buffer_load_dwordx4 v7, s[12:15], s58 offen offset:3072 lds
    v_add_u32 v26, 0, v23
    v_xor_b32 v26, v26, v25
    v_lshlrev_b32 v26, 4, v26
    v_lshl_add_u32 v10, v23, 8, v26
    v_add_u32 v26, 4, v23
    v_xor_b32 v26, v26, v25
    v_lshlrev_b32 v26, 4, v26
    v_lshl_add_u32 v11, v23, 8, v26
    v_add_u32 v26, 8, v23
    v_xor_b32 v26, v26, v25
    v_lshlrev_b32 v26, 4, v26
    v_lshl_add_u32 v12, v23, 8, v26
    v_add_u32 v26, 12, v23
    v_xor_b32 v26, v26, v25
    v_lshlrev_b32 v26, 4, v26
    v_lshl_add_u32 v13, v23, 8, v26
    v_and_b32 v26, 1, v23
    v_lshlrev_b32 v26, 2, v26
    v_xor_b32 v26, v26, v24
    v_lshlrev_b32 v26, 4, v26
    v_mul_u32_u24 v27, 1152, v22
    v_add_u32 v16, v26, v27
    v_lshl_add_u32 v34, v22, 8, v26
    v_lshlrev_b32 v15, 4, v1
    v_add_u32 v15, s76, v15
    s_lshr_b32 s75, s37, 1
    s_mul_i32 s75, s75, 147456
    s_and_b32 s59, s37, 1
    s_mul_i32 s59, s59, 36864
    s_add_u32 s75, s75, s59
    s_lshl_b32 s73, s37, 13
    v_add_u32 v17, 8192, v16
    v_add_u32 v35, 1024, v34
    v_add_u32 v18, 16384, v16
    v_add_u32 v36, 2048, v34
    v_add_u32 v19, 24576, v16
    v_add_u32 v37, 3072, v34
    s_lshl_b32 s38, s7, 4
    s_add_u32 s38, s38, s6
    s_lshl_b32 s38, s38, 18
    s_add_u32 s16, s50, s38
    s_addc_u32 s17, s51, 0
    s_mov_b32 s18, 262144
    s_mov_b32 s19, 0x20000
    s_add_u32 s20, s52, s38
    s_addc_u32 s21, s53, 0
    s_mov_b32 s22, 262144
    s_mov_b32 s23, 0x20000
    s_mul_i32 s38, s6, 294912
    s_add_u32 s24, s56, s38
    s_addc_u32 s25, s57, 0
    s_mov_b32 s26, 294912
    s_mov_b32 s27, 0x20000
    s_lshl_b32 s58, s5, 3
    s_add_u32 s58, s58, s7
    s_mul_i32 s59, s58, 1189888
    s_add_u32 s59, s59, 1024
    s_add_u32 s64, s44, s59
    s_addc_u32 s65, s45, 0
    s_mov_b32 s66, 1179648
    s_mov_b32 s67, 0x20000
    s_mul_i32 s59, s6, 73728
    s_add_u32 s60, s64, s59
    s_addc_u32 s61, s65, 0
    s_mov_b32 s62, 73728
    s_mov_b32 s63, 0x20000
    s_mov_b32 s68, s40
    s_mov_b32 s69, s41
    s_mov_b32 s70, 1179648
    s_mov_b32 s71, 0x20000
    s_lshl_b32 s39, s58, 4
    s_add_u32 s28, s64, 1179648
    s_addc_u32 s29, s65, 0
    s_waitcnt vmcnt(19)
    s_barrier
    s_add_u32 m0, s78, 40960
    s_add_u32 s74, s7, 2
    s_sub_u32 s59, s74, 9
    s_cselect_b32 s74, s74, s59
    s_lshl_b32 s58, s74, 7
    s_add_u32 s58, s58, s79
    buffer_load_dwordx4 v8, s[8:11], s58 offen offset:0 lds
    buffer_load_dwordx4 v9, s[8:11], s58 offen offset:1024 lds
    s_add_u32 m0, s76, 81920
    s_add_u32 s74, s7, 3
    s_sub_u32 s59, s74, 9
    s_cselect_b32 s74, s74, s59
    s_lshl_b32 s58, s74, 19
    s_add_u32 s58, s58, s77
    buffer_load_dwordx4 v4, s[12:15], s58 offen offset:0 lds
    buffer_load_dwordx4 v5, s[12:15], s58 offen offset:1024 lds
    buffer_load_dwordx4 v6, s[12:15], s58 offen offset:2048 lds
    buffer_load_dwordx4 v7, s[12:15], s58 offen offset:3072 lds
    s_add_u32 m0, s76, 98304
    s_add_u32 s74, s7, 3
    s_sub_u32 s59, s74, 9
    s_cselect_b32 s74, s74, s59
    s_lshl_b32 s58, s74, 19
    s_add_u32 s58, s58, s77
    s_add_u32 s58, s58, 262144
    buffer_load_dwordx4 v4, s[12:15], s58 offen offset:0 lds
    buffer_load_dwordx4 v5, s[12:15], s58 offen offset:1024 lds
    buffer_load_dwordx4 v6, s[12:15], s58 offen offset:2048 lds
    buffer_load_dwordx4 v7, s[12:15], s58 offen offset:3072 lds
    s_waitcnt vmcnt(18)
    s_barrier
    s_add_u32 m0, s78, 81920
    s_add_u32 s74, s7, 3
    s_sub_u32 s59, s74, 9
    s_cselect_b32 s74, s74, s59
    s_lshl_b32 s58, s74, 7
    s_add_u32 s58, s58, s79
    buffer_load_dwordx4 v8, s[8:11], s58 offen offset:0 lds
    buffer_load_dwordx4 v9, s[8:11], s58 offen offset:1024 lds
    s_add_u32 m0, s76, 122880
    s_add_u32 s74, s7, 4
    s_sub_u32 s59, s74, 9
    s_cselect_b32 s74, s74, s59
    s_lshl_b32 s58, s74, 19
    s_add_u32 s58, s58, s77
    buffer_load_dwordx4 v4, s[12:15], s58 offen offset:0 lds
    buffer_load_dwordx4 v5, s[12:15], s58 offen offset:1024 lds
    buffer_load_dwordx4 v6, s[12:15], s58 offen offset:2048 lds
    buffer_load_dwordx4 v7, s[12:15], s58 offen offset:3072 lds
    s_add_u32 m0, s76, 139264
    s_add_u32 s74, s7, 4
    s_sub_u32 s59, s74, 9
    s_cselect_b32 s74, s74, s59
    s_lshl_b32 s58, s74, 19
    s_add_u32 s58, s58, s77
    s_add_u32 s58, s58, 262144
    buffer_load_dwordx4 v4, s[12:15], s58 offen offset:0 lds
    buffer_load_dwordx4 v5, s[12:15], s58 offen offset:1024 lds
    buffer_load_dwordx4 v6, s[12:15], s58 offen offset:2048 lds
    buffer_load_dwordx4 v7, s[12:15], s58 offen offset:3072 lds
    s_waitcnt vmcnt(18)
    s_barrier
    s_add_u32 m0, s78, 122880
    s_add_u32 s74, s7, 4
    s_sub_u32 s59, s74, 9
    s_cselect_b32 s74, s74, s59
    s_lshl_b32 s58, s74, 7
    s_add_u32 s58, s58, s79
    buffer_load_dwordx4 v8, s[8:11], s58 offen offset:0 lds
    buffer_load_dwordx4 v9, s[8:11], s58 offen offset:1024 lds
    s_add_u32 s58, s76, 16384
    buffer_load_dwordx4 v[48:51], v10, s[16:19], s58 offen offset:0 nt
    buffer_load_dwordx4 v[52:55], v11, s[16:19], s58 offen offset:1024 nt
    buffer_load_dwordx4 v[56:59], v12, s[16:19], s58 offen offset:2048 nt
    buffer_load_dwordx4 v[60:63], v13, s[16:19], s58 offen offset:3072 nt
    s_add_u32 m0, s76, 0
    s_add_u32 s74, s7, 5
    s_sub_u32 s59, s74, 9
    s_cselect_b32 s74, s74, s59
    s_lshl_b32 s58, s74, 19
    s_add_u32 s58, s58, s77
    buffer_load_dwordx4 v4, s[12:15], s58 offen offset:0 lds
    buffer_load_dwordx4 v5, s[12:15], s58 offen offset:1024 lds
    buffer_load_dwordx4 v6, s[12:15], s58 offen offset:2048 lds
    buffer_load_dwordx4 v7, s[12:15], s58 offen offset:3072 lds
    s_waitcnt vmcnt(18)
    s_barrier
    s_add_u32 m0, s76, 16384
    s_add_u32 s74, s7, 5
    s_sub_u32 s59, s74, 9
    s_cselect_b32 s74, s74, s59
    s_lshl_b32 s58, s74, 19
    s_add_u32 s58, s58, s77
    s_add_u32 s58, s58, 262144
    buffer_load_dwordx4 v4, s[12:15], s58 offen offset:0 lds
    buffer_load_dwordx4 v5, s[12:15], s58 offen offset:1024 lds
    buffer_load_dwordx4 v6, s[12:15], s58 offen offset:2048 lds
    buffer_load_dwordx4 v7, s[12:15], s58 offen offset:3072 lds
    s_add_u32 m0, s78, 0
    s_add_u32 s74, s7, 5
    s_sub_u32 s59, s74, 9
    s_cselect_b32 s74, s74, s59
    s_lshl_b32 s58, s74, 7
    s_add_u32 s58, s58, s79
    buffer_load_dwordx4 v8, s[8:11], s58 offen offset:0 lds
    buffer_load_dwordx4 v9, s[8:11], s58 offen offset:1024 lds
    s_add_u32 m0, s76, 40960
    s_add_u32 s74, s7, 6
    s_sub_u32 s59, s74, 9
    s_cselect_b32 s74, s74, s59
    s_lshl_b32 s58, s74, 19
    s_add_u32 s58, s58, s77
    buffer_load_dwordx4 v4, s[12:15], s58 offen offset:0 lds
    buffer_load_dwordx4 v5, s[12:15], s58 offen offset:1024 lds
    buffer_load_dwordx4 v6, s[12:15], s58 offen offset:2048 lds
    buffer_load_dwordx4 v7, s[12:15], s58 offen offset:3072 lds
    s_waitcnt vmcnt(18)
    s_barrier
    s_add_u32 m0, s76, 57344
    s_add_u32 s74, s7, 6
    s_sub_u32 s59, s74, 9
    s_cselect_b32 s74, s74, s59
    s_lshl_b32 s58, s74, 19
    s_add_u32 s58, s58, s77
    s_add_u32 s58, s58, 262144
    buffer_load_dwordx4 v4, s[12:15], s58 offen offset:0 lds
    buffer_load_dwordx4 v5, s[12:15], s58 offen offset:1024 lds
    buffer_load_dwordx4 v6, s[12:15], s58 offen offset:2048 lds
    buffer_load_dwordx4 v7, s[12:15], s58 offen offset:3072 lds
    s_add_u32 m0, s78, 40960
    s_add_u32 s74, s7, 6
    s_sub_u32 s59, s74, 9
    s_cselect_b32 s74, s74, s59
    s_lshl_b32 s58, s74, 7
    s_add_u32 s58, s58, s79
    buffer_load_dwordx4 v8, s[8:11], s58 offen offset:0 lds
    buffer_load_dwordx4 v9, s[8:11], s58 offen offset:1024 lds
    s_add_u32 m0, s76, 81920
    s_add_u32 s74, s7, 7
    s_sub_u32 s59, s74, 9
    s_cselect_b32 s74, s74, s59
    s_lshl_b32 s58, s74, 19
    s_add_u32 s58, s58, s77
    buffer_load_dwordx4 v4, s[12:15], s58 offen offset:0 lds
    buffer_load_dwordx4 v5, s[12:15], s58 offen offset:1024 lds
    buffer_load_dwordx4 v6, s[12:15], s58 offen offset:2048 lds
    buffer_load_dwordx4 v7, s[12:15], s58 offen offset:3072 lds
    s_add_u32 m0, s76, 98304
    s_add_u32 s74, s7, 7
    s_sub_u32 s59, s74, 9
    s_cselect_b32 s74, s74, s59
    s_lshl_b32 s58, s74, 19
    s_add_u32 s58, s58, s77
    s_add_u32 s58, s58, 262144
    buffer_load_dwordx4 v4, s[12:15], s58 offen offset:0 lds
    buffer_load_dwordx4 v5, s[12:15], s58 offen offset:1024 lds
    buffer_load_dwordx4 v6, s[12:15], s58 offen offset:2048 lds
    buffer_load_dwordx4 v7, s[12:15], s58 offen offset:3072 lds
    s_waitcnt vmcnt(18)
    s_barrier
    s_add_u32 m0, s78, 81920
    s_add_u32 s74, s7, 7
    s_sub_u32 s59, s74, 9
    s_cselect_b32 s74, s74, s59
    s_lshl_b32 s58, s74, 7
    s_add_u32 s58, s58, s79
    buffer_load_dwordx4 v8, s[8:11], s58 offen offset:0 lds
    buffer_load_dwordx4 v9, s[8:11], s58 offen offset:1024 lds
    s_add_u32 m0, s76, 122880
    s_add_u32 s74, s7, 8
    s_sub_u32 s59, s74, 9
    s_cselect_b32 s74, s74, s59
    s_lshl_b32 s58, s74, 19
    s_add_u32 s58, s58, s77
    buffer_load_dwordx4 v4, s[12:15], s58 offen offset:0 lds
    buffer_load_dwordx4 v5, s[12:15], s58 offen offset:1024 lds
    buffer_load_dwordx4 v6, s[12:15], s58 offen offset:2048 lds
    buffer_load_dwordx4 v7, s[12:15], s58 offen offset:3072 lds
    s_add_u32 m0, s76, 139264
    s_add_u32 s74, s7, 8
    s_sub_u32 s59, s74, 9
    s_cselect_b32 s74, s74, s59
    s_lshl_b32 s58, s74, 19
    s_add_u32 s58, s58, s77
    s_add_u32 s58, s58, 262144
    buffer_load_dwordx4 v4, s[12:15], s58 offen offset:0 lds
    buffer_load_dwordx4 v5, s[12:15], s58 offen offset:1024 lds
    buffer_load_dwordx4 v6, s[12:15], s58 offen offset:2048 lds
    buffer_load_dwordx4 v7, s[12:15], s58 offen offset:3072 lds
    s_waitcnt vmcnt(18)
    s_barrier
    s_add_u32 m0, s78, 122880
    s_add_u32 s74, s7, 8
    s_sub_u32 s59, s74, 9
    s_cselect_b32 s74, s74, s59
    s_lshl_b32 s58, s74, 7
    s_add_u32 s58, s58, s79
    buffer_load_dwordx4 v8, s[8:11], s58 offen offset:0 lds
    buffer_load_dwordx4 v9, s[8:11], s58 offen offset:1024 lds
    s_add_u32 s58, s76, 147456
    buffer_load_dwordx4 v[64:67], v10, s[16:19], s58 offen offset:0 nt
    buffer_load_dwordx4 v[68:71], v11, s[16:19], s58 offen offset:1024 nt
    buffer_load_dwordx4 v[72:75], v12, s[16:19], s58 offen offset:2048 nt
    buffer_load_dwordx4 v[76:79], v13, s[16:19], s58 offen offset:3072 nt
    s_add_u32 m0, s76, 0
    s_add_u32 s58, s76, 0
    buffer_load_dwordx4 v10, s[16:19], s58 offen offset:0 nt lds
    buffer_load_dwordx4 v11, s[16:19], s58 offen offset:1024 nt lds
    buffer_load_dwordx4 v12, s[16:19], s58 offen offset:2048 nt lds
    buffer_load_dwordx4 v13, s[16:19], s58 offen offset:3072 nt lds
    s_waitcnt vmcnt(18)
    s_barrier
    s_add_u32 m0, s76, 16384
    s_add_u32 s58, s76, 131072
    buffer_load_dwordx4 v10, s[16:19], s58 offen offset:0 nt lds
    buffer_load_dwordx4 v11, s[16:19], s58 offen offset:1024 nt lds
    buffer_load_dwordx4 v12, s[16:19], s58 offen offset:2048 nt lds
    buffer_load_dwordx4 v13, s[16:19], s58 offen offset:3072 nt lds
    s_waitcnt vmcnt(12)
    s_barrier
    s_add_u32 m0, s76, 65536
    s_add_u32 s58, s76, 32768
    buffer_load_dwordx4 v10, s[16:19], s58 offen offset:0 nt lds
    buffer_load_dwordx4 v11, s[16:19], s58 offen offset:1024 nt lds
    buffer_load_dwordx4 v12, s[16:19], s58 offen offset:2048 nt lds
    buffer_load_dwordx4 v13, s[16:19], s58 offen offset:3072 nt lds
    s_add_u32 m0, s76, 81920
    s_add_u32 s58, s76, 163840
    buffer_load_dwordx4 v10, s[16:19], s58 offen offset:0 nt lds
    buffer_load_dwordx4 v11, s[16:19], s58 offen offset:1024 nt lds
    buffer_load_dwordx4 v12, s[16:19], s58 offen offset:2048 nt lds
    buffer_load_dwordx4 v13, s[16:19], s58 offen offset:3072 nt lds
    s_waitcnt vmcnt(8)
    s_barrier
    s_add_u32 m0, s76, 98304
    s_add_u32 s58, s76, 49152
    buffer_load_dwordx4 v10, s[16:19], s58 offen offset:0 nt lds
    buffer_load_dwordx4 v11, s[16:19], s58 offen offset:1024 nt lds
    buffer_load_dwordx4 v12, s[16:19], s58 offen offset:2048 nt lds
    buffer_load_dwordx4 v13, s[16:19], s58 offen offset:3072 nt lds
    s_add_u32 m0, s76, 114688
    s_add_u32 s58, s76, 180224
    buffer_load_dwordx4 v10, s[16:19], s58 offen offset:0 nt lds
    buffer_load_dwordx4 v11, s[16:19], s58 offen offset:1024 nt lds
    buffer_load_dwordx4 v12, s[16:19], s58 offen offset:2048 nt lds
    buffer_load_dwordx4 v13, s[16:19], s58 offen offset:3072 nt lds
    v_add_u32 v26, 32768, v15
    ds_write_b128 v26, v[48:51] offset:0
    ds_write_b128 v26, v[52:55] offset:1024
    ds_write_b128 v26, v[56:59] offset:2048
    ds_write_b128 v26, v[60:63] offset:3072
    ds_write_b128 v26, v[64:67] offset:16384
    ds_write_b128 v26, v[68:71] offset:17408
    ds_write_b128 v26, v[72:75] offset:18432
    ds_write_b128 v26, v[76:79] offset:19456
    s_waitcnt lgkmcnt(0)
    s_barrier
    s_add_u32 m0, s76, 131072
    s_add_u32 s58, s76, 65536
    buffer_load_dwordx4 v10, s[16:19], s58 offen offset:0 nt lds
    buffer_load_dwordx4 v11, s[16:19], s58 offen offset:1024 nt lds
    buffer_load_dwordx4 v12, s[16:19], s58 offen offset:2048 nt lds
    buffer_load_dwordx4 v13, s[16:19], s58 offen offset:3072 nt lds
    s_add_u32 m0, s76, 147456
    s_add_u32 s58, s76, 196608
    buffer_load_dwordx4 v10, s[16:19], s58 offen offset:0 nt lds
    buffer_load_dwordx4 v11, s[16:19], s58 offen offset:1024 nt lds
    buffer_load_dwordx4 v12, s[16:19], s58 offen offset:2048 nt lds
    buffer_load_dwordx4 v13, s[16:19], s58 offen offset:3072 nt lds
    s_waitcnt vmcnt(16)
    s_barrier
    s_add_u32 m0, s76, 0
    s_add_u32 s58, s76, 81920
    buffer_load_dwordx4 v10, s[16:19], s58 offen offset:0 nt lds
    buffer_load_dwordx4 v11, s[16:19], s58 offen offset:1024 nt lds
    buffer_load_dwordx4 v12, s[16:19], s58 offen offset:2048 nt lds
    buffer_load_dwordx4 v13, s[16:19], s58 offen offset:3072 nt lds
    s_add_u32 m0, s76, 16384
    s_add_u32 s58, s76, 212992
    buffer_load_dwordx4 v10, s[16:19], s58 offen offset:0 nt lds
    buffer_load_dwordx4 v11, s[16:19], s58 offen offset:1024 nt lds
    buffer_load_dwordx4 v12, s[16:19], s58 offen offset:2048 nt lds
    buffer_load_dwordx4 v13, s[16:19], s58 offen offset:3072 nt lds
    s_waitcnt vmcnt(16)
    s_barrier
    s_add_u32 m0, s76, 32768
    s_add_u32 s58, s76, 98304
    buffer_load_dwordx4 v10, s[16:19], s58 offen offset:0 nt lds
    buffer_load_dwordx4 v11, s[16:19], s58 offen offset:1024 nt lds
    buffer_load_dwordx4 v12, s[16:19], s58 offen offset:2048 nt lds
    buffer_load_dwordx4 v13, s[16:19], s58 offen offset:3072 nt lds
    s_add_u32 m0, s76, 49152
    s_add_u32 s58, s76, 229376
    buffer_load_dwordx4 v10, s[16:19], s58 offen offset:0 nt lds
    buffer_load_dwordx4 v11, s[16:19], s58 offen offset:1024 nt lds
    buffer_load_dwordx4 v12, s[16:19], s58 offen offset:2048 nt lds
    buffer_load_dwordx4 v13, s[16:19], s58 offen offset:3072 nt lds
    s_waitcnt vmcnt(16)
    s_barrier
    s_add_u32 m0, s76, 65536
    s_add_u32 s58, s76, 114688
    buffer_load_dwordx4 v10, s[16:19], s58 offen offset:0 nt lds
    buffer_load_dwordx4 v11, s[16:19], s58 offen offset:1024 nt lds
    buffer_load_dwordx4 v12, s[16:19], s58 offen offset:2048 nt lds
    buffer_load_dwordx4 v13, s[16:19], s58 offen offset:3072 nt lds
    s_add_u32 m0, s76, 81920
    s_add_u32 s58, s76, 245760
    buffer_load_dwordx4 v10, s[16:19], s58 offen offset:0 nt lds
    buffer_load_dwordx4 v11, s[16:19], s58 offen offset:1024 nt lds
    buffer_load_dwordx4 v12, s[16:19], s58 offen offset:2048 nt lds
    buffer_load_dwordx4 v13, s[16:19], s58 offen offset:3072 nt lds
    v_mov_b32 v32, s39
    s_cmp_lg_u32 s36, 4
    s_cbranch_scc1 L_ncB
    global_load_dword v33, v32, s[42:43] sc1
L_ncB:
    s_waitcnt vmcnt(16)
    s_barrier
    s_add_u32 m0, s76, 98304
    s_add_u32 s58, s73, 0
    buffer_load_dwordx4 v34, s[20:23], s58 offen offset:0 nt lds
    buffer_load_dwordx4 v35, s[20:23], s58 offen offset:1024 nt lds
    buffer_load_dwordx4 v36, s[20:23], s58 offen offset:2048 nt lds
    buffer_load_dwordx4 v37, s[20:23], s58 offen offset:3072 nt lds
    s_add_u32 m0, s76, 114688
    s_add_u32 s58, s73, 131072
    buffer_load_dwordx4 v34, s[20:23], s58 offen offset:0 nt lds
    buffer_load_dwordx4 v35, s[20:23], s58 offen offset:1024 nt lds
    buffer_load_dwordx4 v36, s[20:23], s58 offen offset:2048 nt lds
    buffer_load_dwordx4 v37, s[20:23], s58 offen offset:3072 nt lds
    s_waitcnt vmcnt(16)
    s_barrier
    s_add_u32 m0, s76, 131072
    s_add_u32 s58, s73, 32768
    buffer_load_dwordx4 v34, s[20:23], s58 offen offset:0 nt lds
    buffer_load_dwordx4 v35, s[20:23], s58 offen offset:1024 nt lds
    buffer_load_dwordx4 v36, s[20:23], s58 offen offset:2048 nt lds
    buffer_load_dwordx4 v37, s[20:23], s58 offen offset:3072 nt lds
    s_add_u32 m0, s76, 147456
    s_add_u32 s58, s73, 163840
    buffer_load_dwordx4 v34, s[20:23], s58 offen offset:0 nt lds
    buffer_load_dwordx4 v35, s[20:23], s58 offen offset:1024 nt lds
    buffer_load_dwordx4 v36, s[20:23], s58 offen offset:2048 nt lds
    buffer_load_dwordx4 v37, s[20:23], s58 offen offset:3072 nt lds
    s_waitcnt vmcnt(16)
    s_barrier
    s_add_u32 m0, s76, 0
    s_add_u32 s58, s73, 65536
    buffer_load_dwordx4 v34, s[20:23], s58 offen offset:0 nt lds
    buffer_load_dwordx4 v35, s[20:23], s58 offen offset:1024 nt lds
    buffer_load_dwordx4 v36, s[20:23], s58 offen offset:2048 nt lds
    buffer_load_dwordx4 v37, s[20:23], s58 offen offset:3072 nt lds
    s_add_u32 m0, s76, 16384
    s_add_u32 s58, s73, 196608
    buffer_load_dwordx4 v34, s[20:23], s58 offen offset:0 nt lds
    buffer_load_dwordx4 v35, s[20:23], s58 offen offset:1024 nt lds
    buffer_load_dwordx4 v36, s[20:23], s58 offen offset:2048 nt lds
    buffer_load_dwordx4 v37, s[20:23], s58 offen offset:3072 nt lds
    s_waitcnt vmcnt(16)
    s_barrier
    s_add_u32 m0, s76, 32768
    s_add_u32 s58, s73, 98304
    buffer_load_dwordx4 v34, s[20:23], s58 offen offset:0 nt lds
    buffer_load_dwordx4 v35, s[20:23], s58 offen offset:1024 nt lds
    buffer_load_dwordx4 v36, s[20:23], s58 offen offset:2048 nt lds
    buffer_load_dwordx4 v37, s[20:23], s58 offen offset:3072 nt lds
    s_add_u32 m0, s76, 49152
    s_add_u32 s58, s73, 229376
    buffer_load_dwordx4 v34, s[20:23], s58 offen offset:0 nt lds
    buffer_load_dwordx4 v35, s[20:23], s58 offen offset:1024 nt lds
    buffer_load_dwordx4 v36, s[20:23], s58 offen offset:2048 nt lds
    buffer_load_dwordx4 v37, s[20:23], s58 offen offset:3072 nt lds
    s_cmp_lg_u32 s36, 4
    s_cbranch_scc1 L_ckB
    s_mov_b32 s58, 0
L_clB:
    v_readfirstlane_b32 s59, v33
    s_add_u32 s58, s58, 1
    s_cmp_eq_u32 s59, 1
    s_cbranch_scc1 L_ckB
    s_cmp_ge_u32 s58, 0x10000
    s_cbranch_scc1 L_ckB
    s_sleep 8
    global_load_dword v33, v32, s[42:43] sc1
    s_waitcnt vmcnt(0)
    s_branch L_clB
L_ckB:
    s_waitcnt vmcnt(16)
    s_barrier
    s_add_u32 m0, s76, 65536
    s_add_u32 s58, s73, 128
    buffer_load_dwordx4 v34, s[20:23], s58 offen offset:0 nt lds
    buffer_load_dwordx4 v35, s[20:23], s58 offen offset:1024 nt lds
    buffer_load_dwordx4 v36, s[20:23], s58 offen offset:2048 nt lds
    buffer_load_dwordx4 v37, s[20:23], s58 offen offset:3072 nt lds
    s_add_u32 m0, s76, 81920
    s_add_u32 s58, s73, 131200
    buffer_load_dwordx4 v34, s[20:23], s58 offen offset:0 nt lds
    buffer_load_dwordx4 v35, s[20:23], s58 offen offset:1024 nt lds
    buffer_load_dwordx4 v36, s[20:23], s58 offen offset:2048 nt lds
    buffer_load_dwordx4 v37, s[20:23], s58 offen offset:3072 nt lds
    s_waitcnt vmcnt(16)
    s_barrier
    s_add_u32 m0, s76, 98304
    s_add_u32 s58, s73, 32896
    buffer_load_dwordx4 v34, s[20:23], s58 offen offset:0 nt lds
    buffer_load_dwordx4 v35, s[20:23], s58 offen offset:1024 nt lds
    buffer_load_dwordx4 v36, s[20:23], s58 offen offset:2048 nt lds
    buffer_load_dwordx4 v37, s[20:23], s58 offen offset:3072 nt lds
    s_add_u32 m0, s76, 114688
    s_add_u32 s58, s73, 163968
    buffer_load_dwordx4 v34, s[20:23], s58 offen offset:0 nt lds
    buffer_load_dwordx4 v35, s[20:23], s58 offen offset:1024 nt lds
    buffer_load_dwordx4 v36, s[20:23], s58 offen offset:2048 nt lds
    buffer_load_dwordx4 v37, s[20:23], s58 offen offset:3072 nt lds
    s_waitcnt vmcnt(16)
    s_barrier
    s_add_u32 m0, s76, 131072
    s_add_u32 s58, s73, 65664
    buffer_load_dwordx4 v34, s[20:23], s58 offen offset:0 nt lds
    buffer_load_dwordx4 v35, s[20:23], s58 offen offset:1024 nt lds
    buffer_load_dwordx4 v36, s[20:23], s58 offen offset:2048 nt lds
    buffer_load_dwordx4 v37, s[20:23], s58 offen offset:3072 nt lds
    s_add_u32 m0, s76, 147456
    s_add_u32 s58, s73, 196736
    buffer_load_dwordx4 v34, s[20:23], s58 offen offset:0 nt lds
    buffer_load_dwordx4 v35, s[20:23], s58 offen offset:1024 nt lds
    buffer_load_dwordx4 v36, s[20:23], s58 offen offset:2048 nt lds
    buffer_load_dwordx4 v37, s[20:23], s58 offen offset:3072 nt lds
    s_waitcnt vmcnt(16)
    s_barrier
    s_add_u32 m0, s76, 0
    s_add_u32 s74, s7, 7
    s_sub_u32 s59, s74, 9
    s_cselect_b32 s74, s74, s59
    s_lshl_b32 s58, s74, 7
    s_add_u32 s58, s58, s75
    buffer_load_dwordx4 v16, s[24:27], s58 offen offset:0 lds
    buffer_load_dwordx4 v17, s[24:27], s58 offen offset:1024 lds
    buffer_load_dwordx4 v18, s[24:27], s58 offen offset:2048 lds
    buffer_load_dwordx4 v19, s[24:27], s58 offen offset:3072 lds
    s_add_u32 m0, s76, 16384
    s_add_u32 s74, s7, 8
    s_sub_u32 s59, s74, 9
    s_cselect_b32 s74, s74, s59
    s_lshl_b32 s58, s74, 7
    s_add_u32 s58, s58, s75
    buffer_load_dwordx4 v16, s[24:27], s58 offen offset:0 lds
    buffer_load_dwordx4 v17, s[24:27], s58 offen offset:1024 lds
    buffer_load_dwordx4 v18, s[24:27], s58 offen offset:2048 lds
    buffer_load_dwordx4 v19, s[24:27], s58 offen offset:3072 lds
    s_waitcnt vmcnt(16)
    s_barrier
    s_add_u32 m0, s76, 65536
    s_mov_b32 s74, s7
    s_lshl_b32 s58, s74, 7
    s_add_u32 s58, s58, s75
    buffer_load_dwordx4 v16, s[24:27], s58 offen offset:0 lds
    buffer_load_dwordx4 v17, s[24:27], s58 offen offset:1024 lds
    buffer_load_dwordx4 v18, s[24:27], s58 offen offset:2048 lds
    buffer_load_dwordx4 v19, s[24:27], s58 offen offset:3072 lds
    s_add_u32 m0, s76, 81920
    s_mov_b32 s74, s7
    s_lshl_b32 s58, s74, 7
    s_add_u32 s58, s58, s75
    s_add_u32 s58, s58, 73728
    buffer_load_dwordx4 v16, s[24:27], s58 offen offset:0 lds
    buffer_load_dwordx4 v17, s[24:27], s58 offen offset:1024 lds
    buffer_load_dwordx4 v18, s[24:27], s58 offen offset:2048 lds
    buffer_load_dwordx4 v19, s[24:27], s58 offen offset:3072 lds
    s_waitcnt vmcnt(16)
    s_barrier
    s_add_u32 m0, s76, 32768
    s_add_u32 s58, s73, 98432
    buffer_load_dwordx4 v34, s[20:23], s58 offen offset:0 nt lds
    buffer_load_dwordx4 v35, s[20:23], s58 offen offset:1024 nt lds
    buffer_load_dwordx4 v36, s[20:23], s58 offen offset:2048 nt lds
    buffer_load_dwordx4 v37, s[20:23], s58 offen offset:3072 nt lds
    s_add_u32 m0, s76, 49152
    s_add_u32 s58, s73, 229504
    buffer_load_dwordx4 v34, s[20:23], s58 offen offset:0 nt lds
    buffer_load_dwordx4 v35, s[20:23], s58 offen offset:1024 nt lds
    buffer_load_dwordx4 v36, s[20:23], s58 offen offset:2048 nt lds
    buffer_load_dwordx4 v37, s[20:23], s58 offen offset:3072 nt lds
    s_waitcnt vmcnt(16)
    s_barrier
    s_add_u32 m0, s76, 98304
    s_add_u32 s74, s7, 1
    s_lshl_b32 s58, s74, 7
    s_add_u32 s58, s58, s75
    buffer_load_dwordx4 v16, s[24:27], s58 offen offset:0 lds
    buffer_load_dwordx4 v17, s[24:27], s58 offen offset:1024 lds
    buffer_load_dwordx4 v18, s[24:27], s58 offen offset:2048 lds
    buffer_load_dwordx4 v19, s[24:27], s58 offen offset:3072 lds
    s_add_u32 m0, s76, 114688
    s_add_u32 s74, s7, 1
    s_lshl_b32 s58, s74, 7
    s_add_u32 s58, s58, s75
    s_add_u32 s58, s58, 73728
    buffer_load_dwordx4 v16, s[24:27], s58 offen offset:0 lds
    buffer_load_dwordx4 v17, s[24:27], s58 offen offset:1024 lds
    buffer_load_dwordx4 v18, s[24:27], s58 offen offset:2048 lds
    buffer_load_dwordx4 v19, s[24:27], s58 offen offset:3072 lds
    s_add_u32 m0, s76, 131072
    s_add_u32 s74, s7, 2
    s_sub_u32 s59, s74, 9
    s_cselect_b32 s74, s74, s59
    s_lshl_b32 s58, s74, 7
    s_add_u32 s58, s58, s75
    buffer_load_dwordx4 v16, s[24:27], s58 offen offset:0 lds
    buffer_load_dwordx4 v17, s[24:27], s58 offen offset:1024 lds
    buffer_load_dwordx4 v18, s[24:27], s58 offen offset:2048 lds
    buffer_load_dwordx4 v19, s[24:27], s58 offen offset:3072 lds
    s_waitcnt vmcnt(12)
    s_barrier
    s_add_u32 m0, s76, 147456
    s_add_u32 s74, s7, 2
    s_sub_u32 s59, s74, 9
    s_cselect_b32 s74, s74, s59
    s_lshl_b32 s58, s74, 7
    s_add_u32 s58, s58, s75
    s_add_u32 s58, s58, 73728
    buffer_load_dwordx4 v16, s[24:27], s58 offen offset:0 lds
    buffer_load_dwordx4 v17, s[24:27], s58 offen offset:1024 lds
    buffer_load_dwordx4 v18, s[24:27], s58 offen offset:2048 lds
    buffer_load_dwordx4 v19, s[24:27], s58 offen offset:3072 lds
    s_add_u32 m0, s76, 0
    s_add_u32 s74, s7, 3
    s_sub_u32 s59, s74, 9
    s_cselect_b32 s74, s74, s59
    s_lshl_b32 s58, s74, 7
    s_add_u32 s58, s58, s75
    buffer_load_dwordx4 v16, s[24:27], s58 offen offset:0 lds
    buffer_load_dwordx4 v17, s[24:27], s58 offen offset:1024 lds
    buffer_load_dwordx4 v18, s[24:27], s58 offen offset:2048 lds
    buffer_load_dwordx4 v19, s[24:27], s58 offen offset:3072 lds
    s_add_u32 m0, s76, 16384
    s_add_u32 s74, s7, 3
    s_sub_u32 s59, s74, 9
    s_cselect_b32 s74, s74, s59
    s_lshl_b32 s58, s74, 7
    s_add_u32 s58, s58, s75
    s_add_u32 s58, s58, 73728
    buffer_load_dwordx4 v16, s[24:27], s58 offen offset:0 lds
    buffer_load_dwordx4 v17, s[24:27], s58 offen offset:1024 lds
    buffer_load_dwordx4 v18, s[24:27], s58 offen offset:2048 lds
    buffer_load_dwordx4 v19, s[24:27], s58 offen offset:3072 lds
    s_barrier
    s_waitcnt vmcnt(16)
    s_barrier
    s_add_u32 m0, s76, 65536
    s_add_u32 s74, s7, 4
    s_sub_u32 s59, s74, 9
    s_cselect_b32 s74, s74, s59
    s_lshl_b32 s58, s74, 7
    s_add_u32 s58, s58, s75
    buffer_load_dwordx4 v16, s[24:27], s58 offen offset:0 lds
    buffer_load_dwordx4 v17, s[24:27], s58 offen offset:1024 lds
    buffer_load_dwordx4 v18, s[24:27], s58 offen offset:2048 lds
    buffer_load_dwordx4 v19, s[24:27], s58 offen offset:3072 lds
    s_add_u32 m0, s76, 81920
    s_add_u32 s74, s7, 4
    s_sub_u32 s59, s74, 9
    s_cselect_b32 s74, s74, s59
    s_lshl_b32 s58, s74, 7
    s_add_u32 s58, s58, s75
    s_add_u32 s58, s58, 73728
    buffer_load_dwordx4 v16, s[24:27], s58 offen offset:0 lds
    buffer_load_dwordx4 v17, s[24:27], s58 offen offset:1024 lds
    buffer_load_dwordx4 v18, s[24:27], s58 offen offset:2048 lds
    buffer_load_dwordx4 v19, s[24:27], s58 offen offset:3072 lds
    s_waitcnt vmcnt(16)
    s_barrier
    s_add_u32 m0, s76, 32768
    s_add_u32 s74, s7, 5
    s_sub_u32 s59, s74, 9
    s_cselect_b32 s74, s74, s59
    s_lshl_b32 s58, s74, 7
    s_add_u32 s58, s58, s75
    buffer_load_dwordx4 v16, s[24:27], s58 offen offset:0 lds
    buffer_load_dwordx4 v17, s[24:27], s58 offen offset:1024 lds
    buffer_load_dwordx4 v18, s[24:27], s58 offen offset:2048 lds
    buffer_load_dwordx4 v19, s[24:27], s58 offen offset:3072 lds
    s_add_u32 m0, s76, 49152
    s_add_u32 s74, s7, 5
    s_sub_u32 s59, s74, 9
    s_cselect_b32 s74, s74, s59
    s_lshl_b32 s58, s74, 7
    s_add_u32 s58, s58, s75
    s_add_u32 s58, s58, 73728
    buffer_load_dwordx4 v16, s[24:27], s58 offen offset:0 lds
    buffer_load_dwordx4 v17, s[24:27], s58 offen offset:1024 lds
    buffer_load_dwordx4 v18, s[24:27], s58 offen offset:2048 lds
    buffer_load_dwordx4 v19, s[24:27], s58 offen offset:3072 lds
    s_waitcnt vmcnt(16)
    s_barrier
    s_add_u32 m0, s76, 98304
    s_add_u32 s74, s7, 6
    s_sub_u32 s59, s74, 9
    s_cselect_b32 s74, s74, s59
    s_lshl_b32 s58, s74, 7
    s_add_u32 s58, s58, s75
    buffer_load_dwordx4 v16, s[24:27], s58 offen offset:0 lds
    buffer_load_dwordx4 v17, s[24:27], s58 offen offset:1024 lds
    buffer_load_dwordx4 v18, s[24:27], s58 offen offset:2048 lds
    buffer_load_dwordx4 v19, s[24:27], s58 offen offset:3072 lds
    s_add_u32 m0, s76, 114688
    s_add_u32 s74, s7, 6
    s_sub_u32 s59, s74, 9
    s_cselect_b32 s74, s74, s59
    s_lshl_b32 s58, s74, 7
    s_add_u32 s58, s58, s75
    s_add_u32 s58, s58, 73728
    buffer_load_dwordx4 v16, s[24:27], s58 offen offset:0 lds
    buffer_load_dwordx4 v17, s[24:27], s58 offen offset:1024 lds
    buffer_load_dwordx4 v18, s[24:27], s58 offen offset:2048 lds
    buffer_load_dwordx4 v19, s[24:27], s58 offen offset:3072 lds
    s_waitcnt vmcnt(16)
    s_barrier
    s_add_u32 m0, s76, 131072
    s_add_u32 s74, s7, 7
    s_sub_u32 s59, s74, 9
    s_cselect_b32 s74, s74, s59
    s_lshl_b32 s58, s74, 7
    s_add_u32 s58, s58, s75
    s_add_u32 s58, s58, 73728
    buffer_load_dwordx4 v16, s[24:27], s58 offen offset:0 lds
    buffer_load_dwordx4 v17, s[24:27], s58 offen offset:1024 lds
    buffer_load_dwordx4 v18, s[24:27], s58 offen offset:2048 lds
    buffer_load_dwordx4 v19, s[24:27], s58 offen offset:3072 lds
    s_add_u32 m0, s76, 147456
    s_add_u32 s74, s7, 8
    s_sub_u32 s59, s74, 9
    s_cselect_b32 s74, s74, s59
    s_lshl_b32 s58, s74, 7
    s_add_u32 s58, s58, s75
    s_add_u32 s58, s58, 73728
    buffer_load_dwordx4 v16, s[24:27], s58 offen offset:0 lds
    buffer_load_dwordx4 v17, s[24:27], s58 offen offset:1024 lds
    buffer_load_dwordx4 v18, s[24:27], s58 offen offset:2048 lds
    buffer_load_dwordx4 v19, s[24:27], s58 offen offset:3072 lds
    s_waitcnt vmcnt(16)
    s_barrier
    s_waitcnt vmcnt(8)
    s_barrier
    v_mov_b32 v26, 0
    v_mov_b32 v28, 0
    v_mov_b32 v29, 0
    ds_write_b64 v26, v[28:29]
    s_waitcnt lgkmcnt(0)
    s_waitcnt vmcnt(0)
    s_barrier
    s_branch L_ldend
L_ldA:
    s_load_dwordx2 s[84:85], s[0:1], 40
    s_load_dwordx4 s[88:91], s[0:1], 64
    v_lshlrev_b32 v44, 7, v1
    v_lshlrev_b32 v45, 7, v22
    v_lshrrev_b32 v46, 2, v1
    v_lshlrev_b32 v46, 13, v46
    v_and_b32 v47, 3, v1
    v_lshl_add_u32 v46, v47, 7, v46
    v_lshlrev_b32 v47, 7, v47
    v_lshl_add_u32 v47, v20, 13, v47
    s_waitcnt lgkmcnt(0)
    s_mul_i32 s38, s6, 294912
    s_add_u32 s96, s90, s38
    s_addc_u32 s97, s91, 0
    s_mov_b32 s98, 294912
    s_mov_b32 s99, 0x20000
    s_lshl_b32 s38, s6, 9
    s_add_u32 s92, s88, s38
    s_addc_u32 s93, s89, 0
    s_mov_b32 s94, 4710912
    s_mov_b32 s95, 0x20000
    s_mul_i32 s38, s7, 73728
    s_add_u32 s84, s84, s38
    s_addc_u32 s85, s85, 0
    s_mov_b32 s86, 73728
    s_mov_b32 s87, 0x20000
    s_and_b32 s58, s6, 1
    s_mul_i32 s58, s58, 36864
    s_mul_i32 s59, s37, 9216
    s_add_u32 s58, s58, s59
    buffer_load_dword v28, v44, s[84:87], s58 offen
    s_add_u32 s58, s58, 8192
    buffer_load_dword v29, v45, s[84:87], s58 offen
    s_getpc_b64 s[58:59]
L_pcA:
    s_lshr_b32 s38, s2, 3
    s_lshl_b32 s38, s38, 2
    s_add_u32 s38, s38, s37
    s_lshl_b32 s38, s38, 9
    s_min_u32 s38, s38, L_codeend-concat_heads__gqa_block_cached__mha_block_cached__near_ridge_kernel-512
    s_sub_u32 s58, s58, L_pcA-concat_heads__gqa_block_cached__mha_block_cached__near_ridge_kernel
    s_subb_u32 s59, s59, 0
    v_lshlrev_b32 v26, 3, v1
    v_add_u32 v26, s38, v26
    global_load_dwordx2 v[30:31], v26, s[58:59]
    v_add_u32 v26, 0, v23
    v_xor_b32 v26, v26, v25
    v_lshlrev_b32 v26, 4, v26
    v_lshl_add_u32 v10, v23, 8, v26
    v_add_u32 v26, 4, v23
    v_xor_b32 v26, v26, v25
    v_lshlrev_b32 v26, 4, v26
    v_lshl_add_u32 v11, v23, 8, v26
    v_add_u32 v26, 8, v23
    v_xor_b32 v26, v26, v25
    v_lshlrev_b32 v26, 4, v26
    v_lshl_add_u32 v12, v23, 8, v26
    v_add_u32 v26, 12, v23
    v_xor_b32 v26, v26, v25
    v_lshlrev_b32 v26, 4, v26
    v_lshl_add_u32 v13, v23, 8, v26
    s_lshl_b32 s38, s7, 4
    s_add_u32 s38, s38, s6
    s_lshl_b32 s38, s38, 17
    s_add_u32 s16, s50, s38
    s_addc_u32 s17, s51, 0
    s_mov_b32 s18, 131072
    s_mov_b32 s19, 0x20000
    s_add_u32 s20, s52, s38
    s_addc_u32 s21, s53, 0
    s_mov_b32 s22, 131072
    s_mov_b32 s23, 0x20000
    s_add_u32 s58, s76, 16384
    buffer_load_dwordx4 v[48:51], v10, s[16:19], s58 offen offset:0 nt
    buffer_load_dwordx4 v[52:55], v11, s[16:19], s58 offen offset:1024 nt
    buffer_load_dwordx4 v[56:59], v12, s[16:19], s58 offen offset:2048 nt
    buffer_load_dwordx4 v[60:63], v13, s[16:19], s58 offen offset:3072 nt
    s_lshl_b32 s38, s6, 9
    s_add_u32 s12, s54, s38
    s_addc_u32 s13, s55, 0
    s_mov_b32 s14, 4710912
    s_mov_b32 s15, 0x20000
    s_mul_i32 s38, s7, 73728
    s_add_u32 s8, s48, s38
    s_addc_u32 s9, s49, 0
    s_mov_b32 s10, 73728
    s_mov_b32 s11, 0x20000
    s_mul_i32 s58, s7, 72
    s_mul_i32 s59, s37, 18
    s_add_u32 s58, s58, s59
    s_lshl_b32 s58, s58, 13
    buffer_load_dword v28, v46, s[12:15], s58 offen
    s_add_u32 s58, s58, 131072
    buffer_load_dword v29, v47, s[12:15], s58 offen
    s_and_b32 s58, s6, 1
    s_mul_i32 s58, s58, 36864
    s_mul_i32 s59, s37, 9216
    s_add_u32 s58, s58, s59
    buffer_load_dword v28, v44, s[8:11], s58 offen
    s_add_u32 s58, s58, 8192
    buffer_load_dword v29, v45, s[8:11], s58 offen
    s_add_u32 s58, s76, 32768
    buffer_load_dwordx4 v[64:67], v10, s[16:19], s58 offen offset:0 nt
    buffer_load_dwordx4 v[68:71], v11, s[16:19], s58 offen offset:1024 nt
    buffer_load_dwordx4 v[72:75], v12, s[16:19], s58 offen offset:2048 nt
    buffer_load_dwordx4 v[76:79], v13, s[16:19], s58 offen offset:3072 nt
    s_add_u32 s58, s76, 49152
    buffer_load_dwordx4 v[80:83], v10, s[16:19], s58 offen offset:0 nt
    buffer_load_dwordx4 v[84:87], v11, s[16:19], s58 offen offset:1024 nt
    buffer_load_dwordx4 v[88:91], v12, s[16:19], s58 offen offset:2048 nt
    buffer_load_dwordx4 v[92:95], v13, s[16:19], s58 offen offset:3072 nt
    s_add_u32 s58, s76, 65536
    buffer_load_dwordx4 v[96:99], v10, s[16:19], s58 offen offset:0 nt
    buffer_load_dwordx4 v[100:103], v11, s[16:19], s58 offen offset:1024 nt
    buffer_load_dwordx4 v[104:107], v12, s[16:19], s58 offen offset:2048 nt
    buffer_load_dwordx4 v[108:111], v13, s[16:19], s58 offen offset:3072 nt
    s_add_u32 s58, s76, 81920
    buffer_load_dwordx4 v[112:115], v10, s[16:19], s58 offen offset:0 nt
    buffer_load_dwordx4 v[116:119], v11, s[16:19], s58 offen offset:1024 nt
    buffer_load_dwordx4 v[120:123], v12, s[16:19], s58 offen offset:2048 nt
    buffer_load_dwordx4 v[124:127], v13, s[16:19], s58 offen offset:3072 nt
    s_add_u32 s58, s76, 98304
    buffer_load_dwordx4 v[128:131], v10, s[16:19], s58 offen offset:0 nt
    buffer_load_dwordx4 v[132:135], v11, s[16:19], s58 offen offset:1024 nt
    buffer_load_dwordx4 v[136:139], v12, s[16:19], s58 offen offset:2048 nt
    buffer_load_dwordx4 v[140:143], v13, s[16:19], s58 offen offset:3072 nt
    s_lshl_b32 s77, s37, 16
    s_lshl_b32 s78, s37, 11
    s_add_u32 s78, s78, 32768
    s_mul_i32 s79, s37, 18432
    v_add_u32 v26, 0, v20
    v_lshlrev_b32 v27, 2, v26
    v_xor_b32 v27, v27, v21
    v_lshlrev_b32 v27, 4, v27
    v_lshl_add_u32 v4, v26, 13, v27
    v_add_u32 v26, 2, v20
    v_lshlrev_b32 v27, 2, v26
    v_xor_b32 v27, v27, v21
    v_lshlrev_b32 v27, 4, v27
    v_lshl_add_u32 v5, v26, 13, v27
    v_subrev_u32 v5, 1024, v5
    v_add_u32 v6, 30720, v4
    v_add_u32 v7, 30720, v5
    v_xor_b32 v27, v23, v24
    v_lshlrev_b32 v27, 4, v27
    v_mul_u32_u24 v26, 1152, v22
    v_add_u32 v8, v26, v27
    v_xor_b32 v27, 64, v27
    v_add_u32 v26, 8192, v26
    v_add_u32 v9, v26, v27
    s_add_u32 m0, s76, 122880
    s_mov_b32 s74, s7
    s_lshl_b32 s58, s74, 19
    s_add_u32 s58, s58, s77
    buffer_load_dwordx4 v4, s[12:15], s58 offen offset:0 lds
    buffer_load_dwordx4 v5, s[12:15], s58 offen offset:1024 lds
    buffer_load_dwordx4 v6, s[12:15], s58 offen offset:2048 lds
    buffer_load_dwordx4 v7, s[12:15], s58 offen offset:3072 lds
    s_add_u32 m0, s76, 139264
    s_mov_b32 s74, s7
    s_lshl_b32 s58, s74, 19
    s_add_u32 s58, s58, s77
    s_add_u32 s58, s58, 262144
    buffer_load_dwordx4 v4, s[12:15], s58 offen offset:0 lds
    buffer_load_dwordx4 v5, s[12:15], s58 offen offset:1024 lds
    buffer_load_dwordx4 v6, s[12:15], s58 offen offset:2048 lds
    buffer_load_dwordx4 v7, s[12:15], s58 offen offset:3072 lds
    s_add_u32 m0, s78, 122880
    s_mov_b32 s74, s7
    s_lshl_b32 s58, s74, 7
    s_add_u32 s58, s58, s79
    buffer_load_dwordx4 v8, s[8:11], s58 offen offset:0 lds
    buffer_load_dwordx4 v9, s[8:11], s58 offen offset:1024 lds
    s_add_u32 m0, s76, 0
    s_add_u32 s74, s7, 1
    s_lshl_b32 s58, s74, 19
    s_add_u32 s58, s58, s77
    buffer_load_dwordx4 v4, s[12:15], s58 offen offset:0 lds
    buffer_load_dwordx4 v5, s[12:15], s58 offen offset:1024 lds
    buffer_load_dwordx4 v6, s[12:15], s58 offen offset:2048 lds
    buffer_load_dwordx4 v7, s[12:15], s58 offen offset:3072 lds
    s_add_u32 m0, s76, 16384
    s_add_u32 s74, s7, 1
    s_lshl_b32 s58, s74, 19
    s_add_u32 s58, s58, s77
    s_add_u32 s58, s58, 262144
    buffer_load_dwordx4 v4, s[12:15], s58 offen offset:0 lds
    buffer_load_dwordx4 v5, s[12:15], s58 offen offset:1024 lds
    buffer_load_dwordx4 v6, s[12:15], s58 offen offset:2048 lds
    buffer_load_dwordx4 v7, s[12:15], s58 offen offset:3072 lds
    s_add_u32 m0, s78, 0
    s_add_u32 s74, s7, 1
    s_lshl_b32 s58, s74, 7
    s_add_u32 s58, s58, s79
    buffer_load_dwordx4 v8, s[8:11], s58 offen offset:0 lds
    buffer_load_dwordx4 v9, s[8:11], s58 offen offset:1024 lds
    v_and_b32 v26, 1, v23
    v_lshlrev_b32 v26, 2, v26
    v_xor_b32 v26, v26, v24
    v_lshlrev_b32 v26, 4, v26
    v_mul_u32_u24 v27, 1152, v22
    v_add_u32 v16, v26, v27
    v_lshl_add_u32 v34, v22, 8, v26
    v_lshlrev_b32 v15, 4, v1
    v_add_u32 v15, s76, v15
    s_lshr_b32 s75, s37, 1
    s_mul_i32 s75, s75, 147456
    s_and_b32 s59, s37, 1
    s_mul_i32 s59, s59, 36864
    s_add_u32 s75, s75, s59
    s_lshl_b32 s73, s37, 13
    v_add_u32 v17, 8192, v16
    v_add_u32 v35, 1024, v34
    v_add_u32 v18, 16384, v16
    v_add_u32 v36, 2048, v34
    v_add_u32 v19, 24576, v16
    v_add_u32 v37, 3072, v34
    s_mul_i32 s38, s6, 294912
    s_add_u32 s24, s56, s38
    s_addc_u32 s25, s57, 0
    s_mov_b32 s26, 294912
    s_mov_b32 s27, 0x20000
    s_lshl_b32 s58, s5, 3
    s_add_u32 s58, s58, s7
    s_mul_i32 s59, s58, 1189888
    s_add_u32 s59, s59, 1024
    s_add_u32 s64, s44, s59
    s_addc_u32 s65, s45, 0
    s_mov_b32 s66, 1179648
    s_mov_b32 s67, 0x20000
    s_mul_i32 s59, s6, 73728
    s_add_u32 s60, s64, s59
    s_addc_u32 s61, s65, 0
    s_mov_b32 s62, 73728
    s_mov_b32 s63, 0x20000
    s_mov_b32 s68, s40
    s_mov_b32 s69, s41
    s_mov_b32 s70, 1179648
    s_mov_b32 s71, 0x20000
    s_lshl_b32 s39, s58, 4
    s_add_u32 s28, s64, 1179648
    s_addc_u32 s29, s65, 0
    s_waitcnt vmcnt(10)
    s_barrier
    s_add_u32 s58, s76, 114688
    buffer_load_dwordx4 v[144:147], v10, s[16:19], s58 offen offset:0 nt
    buffer_load_dwordx4 v[148:151], v11, s[16:19], s58 offen offset:1024 nt
    buffer_load_dwordx4 v[152:155], v12, s[16:19], s58 offen offset:2048 nt
    buffer_load_dwordx4 v[156:159], v13, s[16:19], s58 offen offset:3072 nt
    s_add_u32 m0, s76, 40960
    s_add_u32 s74, s7, 2
    s_sub_u32 s59, s74, 9
    s_cselect_b32 s74, s74, s59
    s_lshl_b32 s58, s74, 19
    s_add_u32 s58, s58, s77
    buffer_load_dwordx4 v4, s[12:15], s58 offen offset:0 lds
    buffer_load_dwordx4 v5, s[12:15], s58 offen offset:1024 lds
    buffer_load_dwordx4 v6, s[12:15], s58 offen offset:2048 lds
    buffer_load_dwordx4 v7, s[12:15], s58 offen offset:3072 lds
    s_add_u32 m0, s76, 57344
    s_add_u32 s74, s7, 2
    s_sub_u32 s59, s74, 9
    s_cselect_b32 s74, s74, s59
    s_lshl_b32 s58, s74, 19
    s_add_u32 s58, s58, s77
    s_add_u32 s58, s58, 262144
    buffer_load_dwordx4 v4, s[12:15], s58 offen offset:0 lds
    buffer_load_dwordx4 v5, s[12:15], s58 offen offset:1024 lds
    buffer_load_dwordx4 v6, s[12:15], s58 offen offset:2048 lds
    buffer_load_dwordx4 v7, s[12:15], s58 offen offset:3072 lds
    s_waitcnt vmcnt(12)
    s_barrier
    s_add_u32 m0, s78, 40960
    s_add_u32 s74, s7, 2
    s_sub_u32 s59, s74, 9
    s_cselect_b32 s74, s74, s59
    s_lshl_b32 s58, s74, 7
    s_add_u32 s58, s58, s79
    buffer_load_dwordx4 v8, s[8:11], s58 offen offset:0 lds
    buffer_load_dwordx4 v9, s[8:11], s58 offen offset:1024 lds
    s_add_u32 m0, s76, 81920
    s_add_u32 s74, s7, 3
    s_sub_u32 s59, s74, 9
    s_cselect_b32 s74, s74, s59
    s_lshl_b32 s58, s74, 19
    s_add_u32 s58, s58, s77
    buffer_load_dwordx4 v4, s[12:15], s58 offen offset:0 lds
    buffer_load_dwordx4 v5, s[12:15], s58 offen offset:1024 lds
    buffer_load_dwordx4 v6, s[12:15], s58 offen offset:2048 lds
    buffer_load_dwordx4 v7, s[12:15], s58 offen offset:3072 lds
    s_add_u32 m0, s76, 98304
    s_add_u32 s74, s7, 3
    s_sub_u32 s59, s74, 9
    s_cselect_b32 s74, s74, s59
    s_lshl_b32 s58, s74, 19
    s_add_u32 s58, s58, s77
    s_add_u32 s58, s58, 262144
    buffer_load_dwordx4 v4, s[12:15], s58 offen offset:0 lds
    buffer_load_dwordx4 v5, s[12:15], s58 offen offset:1024 lds
    buffer_load_dwordx4 v6, s[12:15], s58 offen offset:2048 lds
    buffer_load_dwordx4 v7, s[12:15], s58 offen offset:3072 lds
    s_add_u32 m0, s78, 81920
    s_add_u32 s74, s7, 3
    s_sub_u32 s59, s74, 9
    s_cselect_b32 s74, s74, s59
    s_lshl_b32 s58, s74, 7
    s_add_u32 s58, s58, s79
    buffer_load_dwordx4 v8, s[8:11], s58 offen offset:0 lds
    buffer_load_dwordx4 v9, s[8:11], s58 offen offset:1024 lds
    s_waitcnt vmcnt(10)
    s_barrier
    s_add_u32 s58, s73, 32896
    buffer_load_dwordx4 v[160:163], v34, s[20:23], s58 offen offset:0 nt
    buffer_load_dwordx4 v[164:167], v35, s[20:23], s58 offen offset:1024 nt
    buffer_load_dwordx4 v[168:171], v36, s[20:23], s58 offen offset:2048 nt
    buffer_load_dwordx4 v[172:175], v37, s[20:23], s58 offen offset:3072 nt
    s_add_u32 m0, s76, 122880
    s_add_u32 s74, s7, 4
    s_sub_u32 s59, s74, 9
    s_cselect_b32 s74, s74, s59
    s_lshl_b32 s58, s74, 19
    s_add_u32 s58, s58, s77
    buffer_load_dwordx4 v4, s[12:15], s58 offen offset:0 lds
    buffer_load_dwordx4 v5, s[12:15], s58 offen offset:1024 lds
    buffer_load_dwordx4 v6, s[12:15], s58 offen offset:2048 lds
    buffer_load_dwordx4 v7, s[12:15], s58 offen offset:3072 lds
    s_add_u32 m0, s76, 139264
    s_add_u32 s74, s7, 4
    s_sub_u32 s59, s74, 9
    s_cselect_b32 s74, s74, s59
    s_lshl_b32 s58, s74, 19
    s_add_u32 s58, s58, s77
    s_add_u32 s58, s58, 262144
    buffer_load_dwordx4 v4, s[12:15], s58 offen offset:0 lds
    buffer_load_dwordx4 v5, s[12:15], s58 offen offset:1024 lds
    buffer_load_dwordx4 v6, s[12:15], s58 offen offset:2048 lds
    buffer_load_dwordx4 v7, s[12:15], s58 offen offset:3072 lds
    s_waitcnt vmcnt(12)
    s_barrier
    s_add_u32 m0, s78, 122880
    s_add_u32 s74, s7, 4
    s_sub_u32 s59, s74, 9
    s_cselect_b32 s74, s74, s59
    s_lshl_b32 s58, s74, 7
    s_add_u32 s58, s58, s79
    buffer_load_dwordx4 v8, s[8:11], s58 offen offset:0 lds
    buffer_load_dwordx4 v9, s[8:11], s58 offen offset:1024 lds
    s_add_u32 m0, s76, 0
    s_add_u32 s74, s7, 5
    s_sub_u32 s59, s74, 9
    s_cselect_b32 s74, s74, s59
    s_lshl_b32 s58, s74, 19
    s_add_u32 s58, s58, s77
    buffer_load_dwordx4 v4, s[12:15], s58 offen offset:0 lds
    buffer_load_dwordx4 v5, s[12:15], s58 offen offset:1024 lds
    buffer_load_dwordx4 v6, s[12:15], s58 offen offset:2048 lds
    buffer_load_dwordx4 v7, s[12:15], s58 offen offset:3072 lds
    s_add_u32 m0, s76, 16384
    s_add_u32 s74, s7, 5
    s_sub_u32 s59, s74, 9
    s_cselect_b32 s74, s74, s59
    s_lshl_b32 s58, s74, 19
    s_add_u32 s58, s58, s77
    s_add_u32 s58, s58, 262144
    buffer_load_dwordx4 v4, s[12:15], s58 offen offset:0 lds
    buffer_load_dwordx4 v5, s[12:15], s58 offen offset:1024 lds
    buffer_load_dwordx4 v6, s[12:15], s58 offen offset:2048 lds
    buffer_load_dwordx4 v7, s[12:15], s58 offen offset:3072 lds
    s_add_u32 m0, s78, 0
    s_add_u32 s74, s7, 5
    s_sub_u32 s59, s74, 9
    s_cselect_b32 s74, s74, s59
    s_lshl_b32 s58, s74, 7
    s_add_u32 s58, s58, s79
    buffer_load_dwordx4 v8, s[8:11], s58 offen offset:0 lds
    buffer_load_dwordx4 v9, s[8:11], s58 offen offset:1024 lds
    s_waitcnt vmcnt(10)
    s_barrier
    s_add_u32 s58, s73, 65664
    buffer_load_dwordx4 v[176:179], v34, s[20:23], s58 offen offset:0 nt
    buffer_load_dwordx4 v[180:183], v35, s[20:23], s58 offen offset:1024 nt
    buffer_load_dwordx4 v[184:187], v36, s[20:23], s58 offen offset:2048 nt
    buffer_load_dwordx4 v[188:191], v37, s[20:23], s58 offen offset:3072 nt
    s_add_u32 m0, s76, 40960
    s_add_u32 s74, s7, 6
    s_sub_u32 s59, s74, 9
    s_cselect_b32 s74, s74, s59
    s_lshl_b32 s58, s74, 19
    s_add_u32 s58, s58, s77
    buffer_load_dwordx4 v4, s[12:15], s58 offen offset:0 lds
    buffer_load_dwordx4 v5, s[12:15], s58 offen offset:1024 lds
    buffer_load_dwordx4 v6, s[12:15], s58 offen offset:2048 lds
    buffer_load_dwordx4 v7, s[12:15], s58 offen offset:3072 lds
    s_add_u32 m0, s76, 57344
    s_add_u32 s74, s7, 6
    s_sub_u32 s59, s74, 9
    s_cselect_b32 s74, s74, s59
    s_lshl_b32 s58, s74, 19
    s_add_u32 s58, s58, s77
    s_add_u32 s58, s58, 262144
    buffer_load_dwordx4 v4, s[12:15], s58 offen offset:0 lds
    buffer_load_dwordx4 v5, s[12:15], s58 offen offset:1024 lds
    buffer_load_dwordx4 v6, s[12:15], s58 offen offset:2048 lds
    buffer_load_dwordx4 v7, s[12:15], s58 offen offset:3072 lds
    s_waitcnt vmcnt(12)
    s_barrier
    s_add_u32 m0, s78, 40960
    s_add_u32 s74, s7, 6
    s_sub_u32 s59, s74, 9
    s_cselect_b32 s74, s74, s59
    s_lshl_b32 s58, s74, 7
    s_add_u32 s58, s58, s79
    buffer_load_dwordx4 v8, s[8:11], s58 offen offset:0 lds
    buffer_load_dwordx4 v9, s[8:11], s58 offen offset:1024 lds
    s_add_u32 m0, s76, 81920
    s_add_u32 s74, s7, 7
    s_sub_u32 s59, s74, 9
    s_cselect_b32 s74, s74, s59
    s_lshl_b32 s58, s74, 19
    s_add_u32 s58, s58, s77
    buffer_load_dwordx4 v4, s[12:15], s58 offen offset:0 lds
    buffer_load_dwordx4 v5, s[12:15], s58 offen offset:1024 lds
    buffer_load_dwordx4 v6, s[12:15], s58 offen offset:2048 lds
    buffer_load_dwordx4 v7, s[12:15], s58 offen offset:3072 lds
    s_add_u32 m0, s76, 98304
    s_add_u32 s74, s7, 7
    s_sub_u32 s59, s74, 9
    s_cselect_b32 s74, s74, s59
    s_lshl_b32 s58, s74, 19
    s_add_u32 s58, s58, s77
    s_add_u32 s58, s58, 262144
    buffer_load_dwordx4 v4, s[12:15], s58 offen offset:0 lds
    buffer_load_dwordx4 v5, s[12:15], s58 offen offset:1024 lds
    buffer_load_dwordx4 v6, s[12:15], s58 offen offset:2048 lds
    buffer_load_dwordx4 v7, s[12:15], s58 offen offset:3072 lds
    s_add_u32 m0, s78, 81920
    s_add_u32 s74, s7, 7
    s_sub_u32 s59, s74, 9
    s_cselect_b32 s74, s74, s59
    s_lshl_b32 s58, s74, 7
    s_add_u32 s58, s58, s79
    buffer_load_dwordx4 v8, s[8:11], s58 offen offset:0 lds
    buffer_load_dwordx4 v9, s[8:11], s58 offen offset:1024 lds
    s_waitcnt vmcnt(10)
    s_barrier
    s_add_u32 s58, s73, 98432
    buffer_load_dwordx4 v[192:195], v34, s[20:23], s58 offen offset:0 nt
    buffer_load_dwordx4 v[196:199], v35, s[20:23], s58 offen offset:1024 nt
    buffer_load_dwordx4 v[200:203], v36, s[20:23], s58 offen offset:2048 nt
    buffer_load_dwordx4 v[204:207], v37, s[20:23], s58 offen offset:3072 nt
    s_add_u32 m0, s76, 122880
    s_add_u32 s74, s7, 8
    s_sub_u32 s59, s74, 9
    s_cselect_b32 s74, s74, s59
    s_lshl_b32 s58, s74, 19
    s_add_u32 s58, s58, s77
    buffer_load_dwordx4 v4, s[12:15], s58 offen offset:0 lds
    buffer_load_dwordx4 v5, s[12:15], s58 offen offset:1024 lds
    buffer_load_dwordx4 v6, s[12:15], s58 offen offset:2048 lds
    buffer_load_dwordx4 v7, s[12:15], s58 offen offset:3072 lds
    s_add_u32 m0, s76, 139264
    s_add_u32 s74, s7, 8
    s_sub_u32 s59, s74, 9
    s_cselect_b32 s74, s74, s59
    s_lshl_b32 s58, s74, 19
    s_add_u32 s58, s58, s77
    s_add_u32 s58, s58, 262144
    buffer_load_dwordx4 v4, s[12:15], s58 offen offset:0 lds
    buffer_load_dwordx4 v5, s[12:15], s58 offen offset:1024 lds
    buffer_load_dwordx4 v6, s[12:15], s58 offen offset:2048 lds
    buffer_load_dwordx4 v7, s[12:15], s58 offen offset:3072 lds
    s_waitcnt vmcnt(12)
    s_barrier
    s_add_u32 m0, s78, 122880
    s_add_u32 s74, s7, 8
    s_sub_u32 s59, s74, 9
    s_cselect_b32 s74, s74, s59
    s_lshl_b32 s58, s74, 7
    s_add_u32 s58, s58, s79
    buffer_load_dwordx4 v8, s[8:11], s58 offen offset:0 lds
    buffer_load_dwordx4 v9, s[8:11], s58 offen offset:1024 lds
    s_add_u32 m0, s76, 0
    s_add_u32 s58, s76, 0
    buffer_load_dwordx4 v10, s[16:19], s58 offen offset:0 nt lds
    buffer_load_dwordx4 v11, s[16:19], s58 offen offset:1024 nt lds
    buffer_load_dwordx4 v12, s[16:19], s58 offen offset:2048 nt lds
    buffer_load_dwordx4 v13, s[16:19], s58 offen offset:3072 nt lds
    s_waitcnt vmcnt(4)
    s_barrier
    v_add_u32 v26, 32768, v15
    ds_write_b128 v26, v[48:51] offset:0
    ds_write_b128 v26, v[52:55] offset:1024
    ds_write_b128 v26, v[56:59] offset:2048
    ds_write_b128 v26, v[60:63] offset:3072
    s_waitcnt vmcnt(0) lgkmcnt(0)
    s_barrier
    v_add_u32 v26, 65536, v15
    ds_write_b128 v26, v[64:67] offset:0
    ds_write_b128 v26, v[68:71] offset:1024
    ds_write_b128 v26, v[72:75] offset:2048
    ds_write_b128 v26, v[76:79] offset:3072
    s_waitcnt lgkmcnt(0)
    s_barrier
    v_add_u32 v26, 98304, v15
    ds_write_b128 v26, v[80:83] offset:0
    ds_write_b128 v26, v[84:87] offset:1024
    ds_write_b128 v26, v[88:91] offset:2048
    ds_write_b128 v26, v[92:95] offset:3072
    s_waitcnt lgkmcnt(0)
    s_barrier
    v_add_u32 v26, 131072, v15
    ds_write_b128 v26, v[96:99] offset:0
    ds_write_b128 v26, v[100:103] offset:1024
    ds_write_b128 v26, v[104:107] offset:2048
    ds_write_b128 v26, v[108:111] offset:3072
    s_waitcnt lgkmcnt(0)
    s_barrier
    v_add_u32 v26, 0, v15
    ds_write_b128 v26, v[112:115] offset:0
    ds_write_b128 v26, v[116:119] offset:1024
    ds_write_b128 v26, v[120:123] offset:2048
    ds_write_b128 v26, v[124:127] offset:3072
    s_waitcnt lgkmcnt(0)
    s_barrier
    s_add_u32 m0, s76, 98304
    s_add_u32 s58, s73, 0
    buffer_load_dwordx4 v34, s[20:23], s58 offen offset:0 nt lds
    buffer_load_dwordx4 v35, s[20:23], s58 offen offset:1024 nt lds
    buffer_load_dwordx4 v36, s[20:23], s58 offen offset:2048 nt lds
    buffer_load_dwordx4 v37, s[20:23], s58 offen offset:3072 nt lds
    v_mov_b32 v32, s39
    s_cmp_lg_u32 s36, 4
    s_cbranch_scc1 L_ncA
    global_load_dword v33, v32, s[42:43] sc1
L_ncA:
    v_add_u32 v26, 32768, v15
    ds_write_b128 v26, v[128:131] offset:0
    ds_write_b128 v26, v[132:135] offset:1024
    ds_write_b128 v26, v[136:139] offset:2048
    ds_write_b128 v26, v[140:143] offset:3072
    s_waitcnt lgkmcnt(0)
    s_barrier
    s_add_u32 m0, s76, 131072
    s_add_u32 s58, s73, 32768
    buffer_load_dwordx4 v34, s[20:23], s58 offen offset:0 nt lds
    buffer_load_dwordx4 v35, s[20:23], s58 offen offset:1024 nt lds
    buffer_load_dwordx4 v36, s[20:23], s58 offen offset:2048 nt lds
    buffer_load_dwordx4 v37, s[20:23], s58 offen offset:3072 nt lds
    v_add_u32 v26, 65536, v15
    ds_write_b128 v26, v[144:147] offset:0
    ds_write_b128 v26, v[148:151] offset:1024
    ds_write_b128 v26, v[152:155] offset:2048
    ds_write_b128 v26, v[156:159] offset:3072
    s_waitcnt lgkmcnt(0)
    s_barrier
    s_add_u32 m0, s76, 0
    s_add_u32 s58, s73, 65536
    buffer_load_dwordx4 v34, s[20:23], s58 offen offset:0 nt lds
    buffer_load_dwordx4 v35, s[20:23], s58 offen offset:1024 nt lds
    buffer_load_dwordx4 v36, s[20:23], s58 offen offset:2048 nt lds
    buffer_load_dwordx4 v37, s[20:23], s58 offen offset:3072 nt lds
    s_barrier
    s_add_u32 m0, s76, 32768
    s_add_u32 s58, s73, 98304
    buffer_load_dwordx4 v34, s[20:23], s58 offen offset:0 nt lds
    buffer_load_dwordx4 v35, s[20:23], s58 offen offset:1024 nt lds
    buffer_load_dwordx4 v36, s[20:23], s58 offen offset:2048 nt lds
    buffer_load_dwordx4 v37, s[20:23], s58 offen offset:3072 nt lds
    s_waitcnt vmcnt(12)
    s_barrier
    s_add_u32 m0, s76, 65536
    s_add_u32 s58, s73, 128
    buffer_load_dwordx4 v34, s[20:23], s58 offen offset:0 nt lds
    buffer_load_dwordx4 v35, s[20:23], s58 offen offset:1024 nt lds
    buffer_load_dwordx4 v36, s[20:23], s58 offen offset:2048 nt lds
    buffer_load_dwordx4 v37, s[20:23], s58 offen offset:3072 nt lds
    s_waitcnt vmcnt(12)
    s_barrier
    s_cmp_lg_u32 s36, 4
    s_cbranch_scc1 L_ckA
    s_mov_b32 s58, 0
L_clA:
    v_readfirstlane_b32 s59, v33
    s_add_u32 s58, s58, 1
    s_cmp_eq_u32 s59, 1
    s_cbranch_scc1 L_ckA
    s_cmp_ge_u32 s58, 0x10000
    s_cbranch_scc1 L_ckA
    s_sleep 8
    global_load_dword v33, v32, s[42:43] sc1
    s_waitcnt vmcnt(0)
    s_branch L_clA
L_ckA:
    v_add_u32 v26, 98304, v15
    ds_write_b128 v26, v[160:163] offset:0
    ds_write_b128 v26, v[164:167] offset:1024
    ds_write_b128 v26, v[168:171] offset:2048
    ds_write_b128 v26, v[172:175] offset:3072
    s_waitcnt vmcnt(8) lgkmcnt(0)
    s_barrier
    v_add_u32 v26, 131072, v15
    ds_write_b128 v26, v[176:179] offset:0
    ds_write_b128 v26, v[180:183] offset:1024
    ds_write_b128 v26, v[184:187] offset:2048
    ds_write_b128 v26, v[188:191] offset:3072
    s_waitcnt vmcnt(4) lgkmcnt(0)
    s_barrier
    s_add_u32 m0, s76, 0
    s_add_u32 s74, s7, 7
    s_sub_u32 s59, s74, 9
    s_cselect_b32 s74, s74, s59
    s_lshl_b32 s58, s74, 7
    s_add_u32 s58, s58, s75
    buffer_load_dwordx4 v16, s[24:27], s58 offen offset:0 lds
    buffer_load_dwordx4 v17, s[24:27], s58 offen offset:1024 lds
    buffer_load_dwordx4 v18, s[24:27], s58 offen offset:2048 lds
    buffer_load_dwordx4 v19, s[24:27], s58 offen offset:3072 lds
    s_add_u32 m0, s76, 16384
    s_add_u32 s74, s7, 8
    s_sub_u32 s59, s74, 9
    s_cselect_b32 s74, s74, s59
    s_lshl_b32 s58, s74, 7
    s_add_u32 s58, s58, s75
    buffer_load_dwordx4 v16, s[24:27], s58 offen offset:0 lds
    buffer_load_dwordx4 v17, s[24:27], s58 offen offset:1024 lds
    buffer_load_dwordx4 v18, s[24:27], s58 offen offset:2048 lds
    buffer_load_dwordx4 v19, s[24:27], s58 offen offset:3072 lds
    s_waitcnt vmcnt(8)
    s_barrier
    s_barrier
    s_add_u32 m0, s76, 65536
    s_mov_b32 s74, s7
    s_lshl_b32 s58, s74, 7
    s_add_u32 s58, s58, s75
    buffer_load_dwordx4 v16, s[24:27], s58 offen offset:0 lds
    buffer_load_dwordx4 v17, s[24:27], s58 offen offset:1024 lds
    buffer_load_dwordx4 v18, s[24:27], s58 offen offset:2048 lds
    buffer_load_dwordx4 v19, s[24:27], s58 offen offset:3072 lds
    s_add_u32 m0, s76, 81920
    s_mov_b32 s74, s7
    s_lshl_b32 s58, s74, 7
    s_add_u32 s58, s58, s75
    s_add_u32 s58, s58, 73728
    buffer_load_dwordx4 v16, s[24:27], s58 offen offset:0 lds
    buffer_load_dwordx4 v17, s[24:27], s58 offen offset:1024 lds
    buffer_load_dwordx4 v18, s[24:27], s58 offen offset:2048 lds
    buffer_load_dwordx4 v19, s[24:27], s58 offen offset:3072 lds
    s_barrier
    s_add_u32 m0, s76, 98304
    s_add_u32 s74, s7, 1
    s_lshl_b32 s58, s74, 7
    s_add_u32 s58, s58, s75
    buffer_load_dwordx4 v16, s[24:27], s58 offen offset:0 lds
    buffer_load_dwordx4 v17, s[24:27], s58 offen offset:1024 lds
    buffer_load_dwordx4 v18, s[24:27], s58 offen offset:2048 lds
    buffer_load_dwordx4 v19, s[24:27], s58 offen offset:3072 lds
    s_add_u32 m0, s76, 114688
    s_add_u32 s74, s7, 1
    s_lshl_b32 s58, s74, 7
    s_add_u32 s58, s58, s75
    s_add_u32 s58, s58, 73728
    buffer_load_dwordx4 v16, s[24:27], s58 offen offset:0 lds
    buffer_load_dwordx4 v17, s[24:27], s58 offen offset:1024 lds
    buffer_load_dwordx4 v18, s[24:27], s58 offen offset:2048 lds
    buffer_load_dwordx4 v19, s[24:27], s58 offen offset:3072 lds
    v_add_u32 v26, 32768, v15
    ds_write_b128 v26, v[192:195] offset:0
    ds_write_b128 v26, v[196:199] offset:1024
    ds_write_b128 v26, v[200:203] offset:2048
    ds_write_b128 v26, v[204:207] offset:3072
    s_waitcnt vmcnt(16) lgkmcnt(0)
    s_barrier
    s_add_u32 m0, s76, 131072
    s_add_u32 s74, s7, 2
    s_sub_u32 s59, s74, 9
    s_cselect_b32 s74, s74, s59
    s_lshl_b32 s58, s74, 7
    s_add_u32 s58, s58, s75
    buffer_load_dwordx4 v16, s[24:27], s58 offen offset:0 lds
    buffer_load_dwordx4 v17, s[24:27], s58 offen offset:1024 lds
    buffer_load_dwordx4 v18, s[24:27], s58 offen offset:2048 lds
    buffer_load_dwordx4 v19, s[24:27], s58 offen offset:3072 lds
    s_add_u32 m0, s76, 147456
    s_add_u32 s74, s7, 2
    s_sub_u32 s59, s74, 9
    s_cselect_b32 s74, s74, s59
    s_lshl_b32 s58, s74, 7
    s_add_u32 s58, s58, s75
    s_add_u32 s58, s58, 73728
    buffer_load_dwordx4 v16, s[24:27], s58 offen offset:0 lds
    buffer_load_dwordx4 v17, s[24:27], s58 offen offset:1024 lds
    buffer_load_dwordx4 v18, s[24:27], s58 offen offset:2048 lds
    buffer_load_dwordx4 v19, s[24:27], s58 offen offset:3072 lds
    s_barrier
    s_add_u32 m0, s76, 0
    s_add_u32 s74, s7, 3
    s_sub_u32 s59, s74, 9
    s_cselect_b32 s74, s74, s59
    s_lshl_b32 s58, s74, 7
    s_add_u32 s58, s58, s75
    buffer_load_dwordx4 v16, s[24:27], s58 offen offset:0 lds
    buffer_load_dwordx4 v17, s[24:27], s58 offen offset:1024 lds
    buffer_load_dwordx4 v18, s[24:27], s58 offen offset:2048 lds
    buffer_load_dwordx4 v19, s[24:27], s58 offen offset:3072 lds
    s_add_u32 m0, s76, 16384
    s_add_u32 s74, s7, 3
    s_sub_u32 s59, s74, 9
    s_cselect_b32 s74, s74, s59
    s_lshl_b32 s58, s74, 7
    s_add_u32 s58, s58, s75
    s_add_u32 s58, s58, 73728
    buffer_load_dwordx4 v16, s[24:27], s58 offen offset:0 lds
    buffer_load_dwordx4 v17, s[24:27], s58 offen offset:1024 lds
    buffer_load_dwordx4 v18, s[24:27], s58 offen offset:2048 lds
    buffer_load_dwordx4 v19, s[24:27], s58 offen offset:3072 lds
    s_waitcnt vmcnt(24)
    s_barrier
    s_waitcnt vmcnt(16)
    s_barrier
    s_add_u32 m0, s76, 65536
    s_add_u32 s74, s7, 4
    s_sub_u32 s59, s74, 9
    s_cselect_b32 s74, s74, s59
    s_lshl_b32 s58, s74, 7
    s_add_u32 s58, s58, s75
    buffer_load_dwordx4 v16, s[24:27], s58 offen offset:0 lds
    buffer_load_dwordx4 v17, s[24:27], s58 offen offset:1024 lds
    buffer_load_dwordx4 v18, s[24:27], s58 offen offset:2048 lds
    buffer_load_dwordx4 v19, s[24:27], s58 offen offset:3072 lds
    s_add_u32 m0, s76, 81920
    s_add_u32 s74, s7, 4
    s_sub_u32 s59, s74, 9
    s_cselect_b32 s74, s74, s59
    s_lshl_b32 s58, s74, 7
    s_add_u32 s58, s58, s75
    s_add_u32 s58, s58, 73728
    buffer_load_dwordx4 v16, s[24:27], s58 offen offset:0 lds
    buffer_load_dwordx4 v17, s[24:27], s58 offen offset:1024 lds
    buffer_load_dwordx4 v18, s[24:27], s58 offen offset:2048 lds
    buffer_load_dwordx4 v19, s[24:27], s58 offen offset:3072 lds
    s_waitcnt vmcnt(16)
    s_barrier
    s_add_u32 m0, s76, 32768
    s_add_u32 s74, s7, 5
    s_sub_u32 s59, s74, 9
    s_cselect_b32 s74, s74, s59
    s_lshl_b32 s58, s74, 7
    s_add_u32 s58, s58, s75
    buffer_load_dwordx4 v16, s[24:27], s58 offen offset:0 lds
    buffer_load_dwordx4 v17, s[24:27], s58 offen offset:1024 lds
    buffer_load_dwordx4 v18, s[24:27], s58 offen offset:2048 lds
    buffer_load_dwordx4 v19, s[24:27], s58 offen offset:3072 lds
    s_add_u32 m0, s76, 49152
    s_add_u32 s74, s7, 5
    s_sub_u32 s59, s74, 9
    s_cselect_b32 s74, s74, s59
    s_lshl_b32 s58, s74, 7
    s_add_u32 s58, s58, s75
    s_add_u32 s58, s58, 73728
    buffer_load_dwordx4 v16, s[24:27], s58 offen offset:0 lds
    buffer_load_dwordx4 v17, s[24:27], s58 offen offset:1024 lds
    buffer_load_dwordx4 v18, s[24:27], s58 offen offset:2048 lds
    buffer_load_dwordx4 v19, s[24:27], s58 offen offset:3072 lds
    s_waitcnt vmcnt(16)
    s_barrier
    s_add_u32 m0, s76, 98304
    s_add_u32 s74, s7, 6
    s_sub_u32 s59, s74, 9
    s_cselect_b32 s74, s74, s59
    s_lshl_b32 s58, s74, 7
    s_add_u32 s58, s58, s75
    buffer_load_dwordx4 v16, s[24:27], s58 offen offset:0 lds
    buffer_load_dwordx4 v17, s[24:27], s58 offen offset:1024 lds
    buffer_load_dwordx4 v18, s[24:27], s58 offen offset:2048 lds
    buffer_load_dwordx4 v19, s[24:27], s58 offen offset:3072 lds
    s_add_u32 m0, s76, 114688
    s_add_u32 s74, s7, 6
    s_sub_u32 s59, s74, 9
    s_cselect_b32 s74, s74, s59
    s_lshl_b32 s58, s74, 7
    s_add_u32 s58, s58, s75
    s_add_u32 s58, s58, 73728
    buffer_load_dwordx4 v16, s[24:27], s58 offen offset:0 lds
    buffer_load_dwordx4 v17, s[24:27], s58 offen offset:1024 lds
    buffer_load_dwordx4 v18, s[24:27], s58 offen offset:2048 lds
    buffer_load_dwordx4 v19, s[24:27], s58 offen offset:3072 lds
    s_waitcnt vmcnt(16)
    s_barrier
    s_add_u32 m0, s76, 131072
    s_add_u32 s74, s7, 7
    s_sub_u32 s59, s74, 9
    s_cselect_b32 s74, s74, s59
    s_lshl_b32 s58, s74, 7
    s_add_u32 s58, s58, s75
    s_add_u32 s58, s58, 73728
    buffer_load_dwordx4 v16, s[24:27], s58 offen offset:0 lds
    buffer_load_dwordx4 v17, s[24:27], s58 offen offset:1024 lds
    buffer_load_dwordx4 v18, s[24:27], s58 offen offset:2048 lds
    buffer_load_dwordx4 v19, s[24:27], s58 offen offset:3072 lds
    s_add_u32 m0, s76, 147456
    s_add_u32 s74, s7, 8
    s_sub_u32 s59, s74, 9
    s_cselect_b32 s74, s74, s59
    s_lshl_b32 s58, s74, 7
    s_add_u32 s58, s58, s75
    s_add_u32 s58, s58, 73728
    buffer_load_dwordx4 v16, s[24:27], s58 offen offset:0 lds
    buffer_load_dwordx4 v17, s[24:27], s58 offen offset:1024 lds
    buffer_load_dwordx4 v18, s[24:27], s58 offen offset:2048 lds
    buffer_load_dwordx4 v19, s[24:27], s58 offen offset:3072 lds
    s_waitcnt vmcnt(16)
    s_barrier
    s_waitcnt vmcnt(8)
    s_barrier
    v_mov_b32 v26, 0
    v_mov_b32 v28, 0
    v_mov_b32 v29, 0
    ds_write_b64 v26, v[28:29]
    s_waitcnt lgkmcnt(0)
    s_waitcnt vmcnt(0)
    s_barrier
L_ldend:
    s_and_b32 s58, s6, 1
    s_lshl_b32 s58, s58, 3
    s_lshr_b32 s6, s6, 1
    s_or_b32 s6, s6, s58
    v_mov_b32 v2, 0
    s_cmp_lg_u32 s36, 4
    s_cbranch_scc1 L_red
    v_and_b32 v6, 15, v1
    v_lshlrev_b32 v6, 9, v6
    s_lshr_b32 s58, s6, 2
    s_lshl_b32 s58, s58, 7
    v_add_u32 v6, s58, v6
    s_mov_b32 s58, 0
L_pg:
    s_sleep 0
    ds_read_b32 v9, v2 offset:4
    s_waitcnt lgkmcnt(0)
    v_readfirstlane_b32 s73, v9
    s_nop 0
    s_cmp_lt_u32 s73, 4
    s_cbranch_scc1 L_pg
L_poll:
    global_load_dword v8, v6, s[28:29] sc1
    s_mov_b32 s59, 0
    s_waitcnt vmcnt(0)
    v_cmp_gt_u32 vcc, 5, v8
    s_nop 0
    s_cmp_eq_u64 vcc, 0
    s_cselect_b32 s59, 5, s59
    v_cmp_gt_u32 vcc, 9, v8
    s_nop 0
    s_cmp_eq_u64 vcc, 0
    s_cselect_b32 s59, 9, s59
    v_mov_b32 v16, s59
    ds_write_b32 v2, v16
    s_cmp_eq_u32 s59, 9
    s_cbranch_scc1 L_end
    s_sleep 1
    s_add_u32 s58, s58, 1
    s_cmp_lt_u32 s58, 0x10000
    s_cbranch_scc1 L_poll
    v_mov_b32 v16, 9
    ds_write_b32 v2, v16
    s_branch L_end
L_red:
    s_sub_u32 s74, s36, 5
    v_lshrrev_b32 v5, 4, v1
    v_bfe_u32 v6, v1, 3, 1
    v_and_b32 v7, 7, v1
    v_mul_u32_u24 v3, 73728, v5
    v_lshl_add_u32 v3, v6, 9, v3
    v_lshl_add_u32 v3, v7, 4, v3
    s_lshr_b32 s58, s6, 2
    s_lshl_b32 s58, s58, 11
    s_and_b32 s59, s6, 3
    s_lshl_b32 s59, s59, 7
    s_add_u32 s58, s58, s59
    v_add_u32 v3, s58, v3
    v_mul_u32_u24 v4, 2304, v7
    v_lshl_add_u32 v4, v6, 4, v4
    v_lshl_add_u32 v4, v5, 3, v4
    s_lshl_b32 s58, s7, 3
    s_and_b32 s59, s6, 7
    s_add_u32 s58, s58, s59
    s_mul_i32 s58, s58, 18432
    s_mul_i32 s59, s5, 1152
    s_add_u32 s58, s58, s59
    s_lshr_b32 s59, s6, 3
    s_lshl_b32 s59, s59, 6
    s_add_u32 s58, s58, s59
    v_add_u32 v4, s58, v4
    v_bfe_u32 v7, v1, 1, 3
    v_and_b32 v8, 1, v1
    v_lshlrev_b32 v8, 4, v8
    v_mov_b32 v9, 0x3f80
    v_lshlrev_b32 v8, v8, v9
    v_cmp_eq_u32 vcc, 0, v7
    s_nop 1
    v_cndmask_b32 v12, 0, v8, vcc
    v_cmp_eq_u32 vcc, 1, v7
    s_nop 1
    v_cndmask_b32 v13, 0, v8, vcc
    v_cmp_eq_u32 vcc, 2, v7
    s_nop 1
    v_cndmask_b32 v14, 0, v8, vcc
    v_cmp_eq_u32 vcc, 3, v7
    s_nop 1
    v_cndmask_b32 v15, 0, v8, vcc
    s_add_u32 s58, s74, 0
    s_lshr_b32 s8, s58, 1
    s_and_b32 s58, s58, 1
    s_lshl_b32 s14, s8, 13
    s_lshl_b32 s59, s58, 10
    s_add_u32 s14, s14, s59
    s_add_u32 s20, s8, s7
    s_sub_u32 s59, s20, 9
    s_cselect_b32 s20, s20, s59
    s_lshl_b32 s20, s20, 7
    s_lshl_b32 s58, s58, 5
    s_add_u32 s20, s20, s58
    s_add_u32 s58, s74, 3
    s_lshr_b32 s9, s58, 1
    s_and_b32 s58, s58, 1
    s_lshl_b32 s15, s9, 13
    s_lshl_b32 s59, s58, 10
    s_add_u32 s15, s15, s59
    s_add_u32 s21, s9, s7
    s_sub_u32 s59, s21, 9
    s_cselect_b32 s21, s21, s59
    s_lshl_b32 s21, s21, 7
    s_lshl_b32 s58, s58, 5
    s_add_u32 s21, s21, s58
    s_add_u32 s58, s74, 6
    s_lshr_b32 s10, s58, 1
    s_and_b32 s58, s58, 1
    s_lshl_b32 s16, s10, 13
    s_lshl_b32 s59, s58, 10
    s_add_u32 s16, s16, s59
    s_add_u32 s22, s10, s7
    s_sub_u32 s59, s22, 9
    s_cselect_b32 s22, s22, s59
    s_lshl_b32 s22, s22, 7
    s_lshl_b32 s58, s58, 5
    s_add_u32 s22, s22, s58
    s_add_u32 s58, s74, 9
    s_lshr_b32 s11, s58, 1
    s_and_b32 s58, s58, 1
    s_lshl_b32 s17, s11, 13
    s_lshl_b32 s59, s58, 10
    s_add_u32 s17, s17, s59
    s_add_u32 s23, s11, s7
    s_sub_u32 s59, s23, 9
    s_cselect_b32 s23, s23, s59
    s_lshl_b32 s23, s23, 7
    s_lshl_b32 s58, s58, 5
    s_add_u32 s23, s23, s58
    s_add_u32 s58, s74, 12
    s_lshr_b32 s12, s58, 1
    s_and_b32 s58, s58, 1
    s_lshl_b32 s18, s12, 13
    s_lshl_b32 s59, s58, 10
    s_add_u32 s18, s18, s59
    s_add_u32 s24, s12, s7
    s_sub_u32 s59, s24, 9
    s_cselect_b32 s24, s24, s59
    s_lshl_b32 s24, s24, 7
    s_lshl_b32 s58, s58, 5
    s_add_u32 s24, s24, s58
    s_add_u32 s58, s74, 15
    s_lshr_b32 s13, s58, 1
    s_and_b32 s58, s58, 1
    s_lshl_b32 s19, s13, 13
    s_lshl_b32 s59, s58, 10
    s_add_u32 s19, s19, s59
    s_add_u32 s25, s13, s7
    s_sub_u32 s59, s25, 9
    s_cselect_b32 s25, s25, s59
    s_lshl_b32 s25, s25, 7
    s_lshl_b32 s58, s58, 5
    s_add_u32 s25, s25, s58
    s_mov_b32 s73, 0
    s_cmp_gt_u32 s73, s8
    s_cbranch_scc1 L_go0
L_w0:
    s_sleep 0
    ds_read_b32 v9, v2
    s_waitcnt lgkmcnt(0)
    v_readfirstlane_b32 s73, v9
    s_nop 0
    s_cmp_gt_u32 s73, s8
    s_cbranch_scc0 L_w0
L_go0:
    buffer_load_dwordx4 v[64:67], v3, s[64:67], s14 offen sc1
    s_add_u32 s14, s14, 294912
    buffer_load_dwordx4 v[68:71], v3, s[64:67], s14 offen sc1
    s_add_u32 s14, s14, 294912
    buffer_load_dwordx4 v[72:75], v3, s[64:67], s14 offen sc1
    s_add_u32 s14, s14, 294912
    buffer_load_dwordx4 v[76:79], v3, s[64:67], s14 offen sc1
    s_cmp_gt_u32 s73, s9
    s_cbranch_scc1 L_go1
L_w1:
    s_sleep 0
    ds_read_b32 v9, v2
    s_waitcnt lgkmcnt(0)
    v_readfirstlane_b32 s73, v9
    s_nop 0
    s_cmp_gt_u32 s73, s9
    s_cbranch_scc0 L_w1
L_go1:
    buffer_load_dwordx4 v[80:83], v3, s[64:67], s15 offen sc1
    s_add_u32 s15, s15, 294912
    buffer_load_dwordx4 v[84:87], v3, s[64:67], s15 offen sc1
    s_add_u32 s15, s15, 294912
    buffer_load_dwordx4 v[88:91], v3, s[64:67], s15 offen sc1
    s_add_u32 s15, s15, 294912
    buffer_load_dwordx4 v[92:95], v3, s[64:67], s15 offen sc1
    s_cmp_gt_u32 s73, s10
    s_cbranch_scc1 L_go2
L_w2:
    s_sleep 0
    ds_read_b32 v9, v2
    s_waitcnt lgkmcnt(0)
    v_readfirstlane_b32 s73, v9
    s_nop 0
    s_cmp_gt_u32 s73, s10
    s_cbranch_scc0 L_w2
L_go2:
    buffer_load_dwordx4 v[96:99], v3, s[64:67], s16 offen sc1
    s_add_u32 s16, s16, 294912
    buffer_load_dwordx4 v[100:103], v3, s[64:67], s16 offen sc1
    s_add_u32 s16, s16, 294912
    buffer_load_dwordx4 v[104:107], v3, s[64:67], s16 offen sc1
    s_add_u32 s16, s16, 294912
    buffer_load_dwordx4 v[108:111], v3, s[64:67], s16 offen sc1
    s_cmp_gt_u32 s73, s11
    s_cbranch_scc1 L_go3
L_w3:
    s_sleep 0
    ds_read_b32 v9, v2
    s_waitcnt lgkmcnt(0)
    v_readfirstlane_b32 s73, v9
    s_nop 0
    s_cmp_gt_u32 s73, s11
    s_cbranch_scc0 L_w3
L_go3:
    buffer_load_dwordx4 v[112:115], v3, s[64:67], s17 offen sc1
    s_add_u32 s17, s17, 294912
    buffer_load_dwordx4 v[116:119], v3, s[64:67], s17 offen sc1
    s_add_u32 s17, s17, 294912
    buffer_load_dwordx4 v[120:123], v3, s[64:67], s17 offen sc1
    s_add_u32 s17, s17, 294912
    buffer_load_dwordx4 v[124:127], v3, s[64:67], s17 offen sc1
    s_cmp_gt_u32 s73, s12
    s_cbranch_scc1 L_go4
L_w4:
    s_sleep 0
    ds_read_b32 v9, v2
    s_waitcnt lgkmcnt(0)
    v_readfirstlane_b32 s73, v9
    s_nop 0
    s_cmp_gt_u32 s73, s12
    s_cbranch_scc0 L_w4
L_go4:
    buffer_load_dwordx4 v[128:131], v3, s[64:67], s18 offen sc1
    s_add_u32 s18, s18, 294912
    buffer_load_dwordx4 v[132:135], v3, s[64:67], s18 offen sc1
    s_add_u32 s18, s18, 294912
    buffer_load_dwordx4 v[136:139], v3, s[64:67], s18 offen sc1
    s_add_u32 s18, s18, 294912
    buffer_load_dwordx4 v[140:143], v3, s[64:67], s18 offen sc1
    s_cmp_gt_u32 s73, s13
    s_cbranch_scc1 L_go5
L_w5:
    s_sleep 0
    ds_read_b32 v9, v2
    s_waitcnt lgkmcnt(0)
    v_readfirstlane_b32 s73, v9
    s_nop 0
    s_cmp_gt_u32 s73, s13
    s_cbranch_scc0 L_w5
L_go5:
    buffer_load_dwordx4 v[144:147], v3, s[64:67], s19 offen sc1
    s_add_u32 s19, s19, 294912
    buffer_load_dwordx4 v[148:151], v3, s[64:67], s19 offen sc1
    s_add_u32 s19, s19, 294912
    buffer_load_dwordx4 v[152:155], v3, s[64:67], s19 offen sc1
    s_add_u32 s19, s19, 294912
    buffer_load_dwordx4 v[156:159], v3, s[64:67], s19 offen sc1
    s_waitcnt vmcnt(8)
    v_mfma_f32_16x16x32_bf16 v[32:35], v[12:15], v[64:67], 0
    v_mfma_f32_16x16x32_bf16 v[36:39], v[12:15], v[80:83], 0
    v_mfma_f32_16x16x32_bf16 v[40:43], v[12:15], v[96:99], 0
    v_mfma_f32_16x16x32_bf16 v[44:47], v[12:15], v[112:115], 0
    v_mfma_f32_16x16x32_bf16 v[32:35], v[12:15], v[68:71], v[32:35]
    v_mfma_f32_16x16x32_bf16 v[36:39], v[12:15], v[84:87], v[36:39]
    v_mfma_f32_16x16x32_bf16 v[40:43], v[12:15], v[100:103], v[40:43]
    v_mfma_f32_16x16x32_bf16 v[44:47], v[12:15], v[116:119], v[44:47]
    v_mfma_f32_16x16x32_bf16 v[32:35], v[12:15], v[72:75], v[32:35]
    v_mfma_f32_16x16x32_bf16 v[36:39], v[12:15], v[88:91], v[36:39]
    v_mfma_f32_16x16x32_bf16 v[40:43], v[12:15], v[104:107], v[40:43]
    v_mfma_f32_16x16x32_bf16 v[44:47], v[12:15], v[120:123], v[44:47]
    v_mfma_f32_16x16x32_bf16 v[32:35], v[12:15], v[76:79], v[32:35]
    v_mfma_f32_16x16x32_bf16 v[36:39], v[12:15], v[92:95], v[36:39]
    v_mfma_f32_16x16x32_bf16 v[40:43], v[12:15], v[108:111], v[40:43]
    v_mfma_f32_16x16x32_bf16 v[44:47], v[12:15], v[124:127], v[44:47]
    s_mov_b32 exec_hi, 0
    s_nop 7
    v_cvt_pk_bf16_f32 v16, v32, v33
    v_cvt_pk_bf16_f32 v17, v34, v35
    buffer_store_dwordx2 v[16:17], v4, s[68:71], s20 offen
    v_cvt_pk_bf16_f32 v18, v36, v37
    v_cvt_pk_bf16_f32 v19, v38, v39
    buffer_store_dwordx2 v[18:19], v4, s[68:71], s21 offen
    v_cvt_pk_bf16_f32 v20, v40, v41
    v_cvt_pk_bf16_f32 v21, v42, v43
    buffer_store_dwordx2 v[20:21], v4, s[68:71], s22 offen
    v_cvt_pk_bf16_f32 v22, v44, v45
    v_cvt_pk_bf16_f32 v23, v46, v47
    buffer_store_dwordx2 v[22:23], v4, s[68:71], s23 offen
    s_mov_b32 exec_hi, -1
    s_waitcnt vmcnt(4)
    v_mfma_f32_16x16x32_bf16 v[48:51], v[12:15], v[128:131], 0
    v_mfma_f32_16x16x32_bf16 v[52:55], v[12:15], v[144:147], 0
    v_mfma_f32_16x16x32_bf16 v[48:51], v[12:15], v[132:135], v[48:51]
    v_mfma_f32_16x16x32_bf16 v[52:55], v[12:15], v[148:151], v[52:55]
    v_mfma_f32_16x16x32_bf16 v[48:51], v[12:15], v[136:139], v[48:51]
    v_mfma_f32_16x16x32_bf16 v[52:55], v[12:15], v[152:155], v[52:55]
    v_mfma_f32_16x16x32_bf16 v[48:51], v[12:15], v[140:143], v[48:51]
    v_mfma_f32_16x16x32_bf16 v[52:55], v[12:15], v[156:159], v[52:55]
    s_mov_b32 exec_hi, 0
    s_nop 9
    v_cvt_pk_bf16_f32 v24, v48, v49
    v_cvt_pk_bf16_f32 v25, v50, v51
    buffer_store_dwordx2 v[24:25], v4, s[68:71], s24 offen
    v_cvt_pk_bf16_f32 v26, v52, v53
    v_cvt_pk_bf16_f32 v27, v54, v55
    buffer_store_dwordx2 v[26:27], v4, s[68:71], s25 offen
    s_mov_b32 exec_hi, -1
    s_endpgm
.p2align 6
L_compute:
    s_lshr_b32 s37, s36, 1
    s_and_b32 s38, s36, 1
    v_lshrrev_b32 v24, 5, v1
    v_bfe_u32 v25, v1, 4, 1
    v_bfe_u32 v26, v1, 2, 2
    v_and_b32 v27, 1, v1
    v_bfe_u32 v28, v1, 1, 1
    v_lshlrev_b32 v29, 5, v25
    v_lshl_add_u32 v30, v27, 4, v29
    v_lshl_add_u32 v30, v28, 3, v30
    v_lshl_add_u32 v31, v28, 4, v29
    v_lshl_add_u32 v31, v27, 3, v31
    v_lshlrev_b32 v2, 12, v24
    v_mul_u32_u24 v29, 576, v26
    v_add3_u32 v2, v2, v29, v30
    s_lshl_b32 s58, s37, 8
    v_add_u32 v2, s58, v2
    v_and_b32 v29, 31, v1
    v_bfe_u32 v27, v1, 1, 3
    v_xor_b32 v27, v27, v24
    v_lshlrev_b32 v27, 4, v27
    v_lshl_add_u32 v3, v29, 7, v27
    s_lshl_b32 s58, s38, 12
    s_add_u32 s58, s58, 32768
    v_add_u32 v3, s58, v3
    s_lshl_b32 s58, s37, 14
    s_mul_i32 s58, s58, s5
    v_and_b32 v27, 15, v1
    v_xor_b32 v27, v27, v24
    v_lshlrev_b32 v27, 4, v27
    v_lshl_add_u32 v16, v29, 8, v27
    v_add_u32 v16, s58, v16
    v_lshlrev_b32 v29, 9, v24
    v_lshl_add_u32 v29, v26, 7, v29
    v_lshrrev_b32 v27, 1, v26
    v_lshl_add_u32 v8, v27, 6, v29
    v_add3_u32 v8, v8, v31, s58
    v_xor_b32 v27, s37, v27
    v_lshl_add_u32 v12, v27, 6, v29
    s_lshl_b32 s58, s37, 13
    v_add3_u32 v12, v12, v30, s58
    v_lshlrev_b32 v13, 4, v1
    s_lshl_b32 s58, s36, 12
    s_add_u32 s58, s58, 32768
    v_add_u32 v14, s58, v13
    s_mov_b32 s30, 0xffff0000
    s_mov_b32 s31, 0
    v_mov_b32 v15, 0xff800000
    v_mov_b32 v10, 0
    v_mov_b32 v11, 0
    v_add_u32 v27, -1, v24
    v_and_b32 v4, 0x3f803f80, v27
    v_and_b32 v5, 0x3f80, v27
    v_mov_b32 v6, 0
    v_mov_b32 v7, 0
    s_mov_b32 s72, 0x3e0293ee
    s_waitcnt lgkmcnt(0)
    s_lshl_b32 s58, s5, 3
    s_add_u32 s58, s58, s7
    s_mul_i32 s59, s58, 1189888
    s_add_u32 s59, s59, 1024
    s_add_u32 s64, s44, s59
    s_addc_u32 s65, s45, 0
    s_mov_b32 s66, 1179648
    s_mov_b32 s67, 0x20000
    s_mul_i32 s59, s6, 73728
    s_add_u32 s60, s64, s59
    s_addc_u32 s61, s65, 0
    s_mov_b32 s62, 73728
    s_mov_b32 s63, 0x20000
    s_mov_b32 s68, s40
    s_mov_b32 s69, s41
    s_mov_b32 s70, 1179648
    s_mov_b32 s71, 0x20000
    s_lshl_b32 s39, s58, 4
    s_add_u32 s28, s64, 1179648
    s_addc_u32 s29, s65, 0
    s_lshl_b32 s58, s36, 11
    v_add_u32 v13, s58, v13
    s_lshl_b32 s58, s6, 9
    s_lshl_b32 s59, s36, 7
    s_add_u32 s59, s59, s58
    v_mov_b32 v0, s59
    s_or_b32 s58, s36, s6
    s_cmp_lg_u32 s58, 0
    s_cbranch_scc1 L_noclr
    v_lshlrev_b32 v24, 4, v1
    v_mov_b32 v28, 0
    v_mov_b32 v29, 0
    v_mov_b32 v30, 0
    v_mov_b32 v31, 0
    v_mov_b32 v26, s39
    v_mov_b32 v27, 1
    global_store_dwordx4 v24, v[28:31], s[28:29] offset:0 sc1
    global_store_dwordx4 v24, v[28:31], s[28:29] offset:1024 sc1
    global_store_dwordx4 v24, v[28:31], s[28:29] offset:2048 sc1
    global_store_dwordx4 v24, v[28:31], s[28:29] offset:3072 sc1
    v_add_u32 v24, 4096, v24
    global_store_dwordx4 v24, v[28:31], s[28:29] offset:0 sc1
    global_store_dwordx4 v24, v[28:31], s[28:29] offset:1024 sc1
    global_store_dwordx4 v24, v[28:31], s[28:29] offset:2048 sc1
    global_store_dwordx4 v24, v[28:31], s[28:29] offset:3072 sc1
    v_add_u32 v24, 4096, v24
    s_mov_b64 exec, 1
    s_waitcnt vmcnt(0)
    global_store_dword v26, v27, s[42:43] sc1
    s_mov_b64 exec, -1
L_noclr:
    v_mov_b32 v1, v16
    v_mov_b32 v25, 1.0
    v_mov_b32 v26, 1.0
    v_mov_b32 v27, 1.0
    v_mov_b32 v28, 1.0
    v_mov_b32 v29, 1.0
    v_mov_b32 v30, 1.0
    v_mov_b32 v31, 1.0
    v_add_u32 v16, 122880, v2
    v_xor_b32 v17, 64, v16
    v_xor_b32 v18, 128, v16
    v_xor_b32 v19, 192, v16
    v_add_u32 v20, 122880, v3
    v_xor_b32 v21, 32, v20
    v_xor_b32 v22, 64, v20
    v_xor_b32 v23, 96, v20
    s_waitcnt lgkmcnt(0)
    s_barrier
    ds_read_b128 v[96:99], v20
    ds_read_b64_tr_b16 v[32:33], v16 offset:0
    ds_read_b64_tr_b16 v[34:35], v16 offset:2048
    ds_read_b64_tr_b16 v[36:37], v17 offset:0
    ds_read_b64_tr_b16 v[38:39], v17 offset:2048
    ds_read_b64_tr_b16 v[40:41], v18 offset:0
    ds_read_b64_tr_b16 v[42:43], v18 offset:2048
    ds_read_b64_tr_b16 v[44:45], v19 offset:0
    ds_read_b64_tr_b16 v[46:47], v19 offset:2048
    ds_read_b128 v[100:103], v21
    ds_read_b64_tr_b16 v[48:49], v16 offset:8192
    ds_read_b64_tr_b16 v[50:51], v16 offset:10240
    ds_read_b64_tr_b16 v[52:53], v17 offset:8192
    ds_read_b64_tr_b16 v[54:55], v17 offset:10240
    s_waitcnt lgkmcnt(5)
    v_mfma_f32_32x32x16_bf16 v[128:143], v[32:35], v[96:99], 0
    ds_read_b64_tr_b16 v[56:57], v18 offset:8192
    ds_read_b64_tr_b16 v[58:59], v18 offset:10240
    v_mfma_f32_32x32x16_bf16 v[144:159], v[36:39], v[96:99], 0
    ds_read_b64_tr_b16 v[60:61], v19 offset:8192
    ds_read_b64_tr_b16 v[62:63], v19 offset:10240
    v_mfma_f32_32x32x16_bf16 v[160:175], v[40:43], v[96:99], 0
    ds_read_b128 v[104:107], v22
    ds_read_b64_tr_b16 v[32:33], v16 offset:16384
    ds_read_b64_tr_b16 v[34:35], v16 offset:18432
    ds_read_b64_tr_b16 v[36:37], v17 offset:16384
    ds_read_b64_tr_b16 v[38:39], v17 offset:18432
    v_mfma_f32_32x32x16_bf16 v[176:191], v[44:47], v[96:99], 0
    ds_read_b64_tr_b16 v[40:41], v18 offset:16384
    s_waitcnt lgkmcnt(14)
    ds_read_b64_tr_b16 v[42:43], v18 offset:18432
    s_waitcnt lgkmcnt(7)
    v_mfma_f32_32x32x16_bf16 v[128:143], v[48:51], v[100:103], v[128:143]
    ds_read_b64_tr_b16 v[44:45], v19 offset:16384
    ds_read_b64_tr_b16 v[46:47], v19 offset:18432
    v_mfma_f32_32x32x16_bf16 v[144:159], v[52:55], v[100:103], v[144:159]
    ds_read_b128 v[108:111], v23
    ds_read_b64_tr_b16 v[48:49], v16 offset:24576
    ds_read_b64_tr_b16 v[50:51], v16 offset:26624
    v_mfma_f32_32x32x16_bf16 v[160:175], v[56:59], v[100:103], v[160:175]
    ds_read_b64_tr_b16 v[52:53], v17 offset:24576
    ds_read_b64_tr_b16 v[54:55], v17 offset:26624
    v_mfma_f32_32x32x16_bf16 v[176:191], v[60:63], v[100:103], v[176:191]
    ds_read_b64_tr_b16 v[56:57], v18 offset:24576
    s_waitcnt lgkmcnt(14)
    ds_read_b64_tr_b16 v[58:59], v18 offset:26624
    s_waitcnt lgkmcnt(7)
    v_mfma_f32_32x32x16_bf16 v[128:143], v[32:35], v[104:107], v[128:143]
    ds_read_b64_tr_b16 v[60:61], v19 offset:24576
    ds_read_b64_tr_b16 v[62:63], v19 offset:26624
    v_mfma_f32_32x32x16_bf16 v[144:159], v[36:39], v[104:107], v[144:159]
    v_mov_b32 v16, v2
    v_xor_b32 v17, 64, v16
    v_xor_b32 v18, 128, v16
    v_xor_b32 v19, 192, v16
    v_mfma_f32_32x32x16_bf16 v[160:175], v[40:43], v[104:107], v[160:175]
    v_mov_b32 v20, v3
    v_xor_b32 v21, 32, v20
    v_xor_b32 v22, 64, v20
    v_xor_b32 v23, 96, v20
    v_mfma_f32_32x32x16_bf16 v[176:191], v[44:47], v[104:107], v[176:191]
    s_waitcnt lgkmcnt(0)
    s_barrier
    ds_read_b128 v[96:99], v20
    ds_read_b64_tr_b16 v[32:33], v16 offset:0
    ds_read_b64_tr_b16 v[34:35], v16 offset:2048
    ds_read_b64_tr_b16 v[36:37], v17 offset:0
    ds_read_b64_tr_b16 v[38:39], v17 offset:2048
    v_mfma_f32_32x32x16_bf16 v[128:143], v[48:51], v[108:111], v[128:143]
    ds_read_b64_tr_b16 v[40:41], v18 offset:0
    ds_read_b64_tr_b16 v[42:43], v18 offset:2048
    v_mfma_f32_32x32x16_bf16 v[144:159], v[52:55], v[108:111], v[144:159]
    ds_read_b64_tr_b16 v[44:45], v19 offset:0
    ds_read_b64_tr_b16 v[46:47], v19 offset:2048
    v_mfma_f32_32x32x16_bf16 v[160:175], v[56:59], v[108:111], v[160:175]
    ds_read_b128 v[100:103], v21
    ds_read_b64_tr_b16 v[48:49], v16 offset:8192
    ds_read_b64_tr_b16 v[50:51], v16 offset:10240
    v_mfma_f32_32x32x16_bf16 v[176:191], v[60:63], v[108:111], v[176:191]
    ds_read_b64_tr_b16 v[52:53], v17 offset:8192
    ds_read_b64_tr_b16 v[54:55], v17 offset:10240
    s_waitcnt lgkmcnt(5)
    v_mfma_f32_32x32x16_bf16 v[128:143], v[32:35], v[96:99], v[128:143]
    ds_read_b64_tr_b16 v[56:57], v18 offset:8192
    ds_read_b64_tr_b16 v[58:59], v18 offset:10240
    v_mfma_f32_32x32x16_bf16 v[144:159], v[36:39], v[96:99], v[144:159]
    ds_read_b64_tr_b16 v[60:61], v19 offset:8192
    ds_read_b64_tr_b16 v[62:63], v19 offset:10240
    v_mfma_f32_32x32x16_bf16 v[160:175], v[40:43], v[96:99], v[160:175]
    ds_read_b128 v[104:107], v22
    ds_read_b64_tr_b16 v[32:33], v16 offset:16384
    ds_read_b64_tr_b16 v[34:35], v16 offset:18432
    ds_read_b64_tr_b16 v[36:37], v17 offset:16384
    ds_read_b64_tr_b16 v[38:39], v17 offset:18432
    v_mfma_f32_32x32x16_bf16 v[176:191], v[44:47], v[96:99], v[176:191]
    ds_read_b64_tr_b16 v[40:41], v18 offset:16384
    s_waitcnt lgkmcnt(14)
    ds_read_b64_tr_b16 v[42:43], v18 offset:18432
    s_waitcnt lgkmcnt(7)
    v_mfma_f32_32x32x16_bf16 v[128:143], v[48:51], v[100:103], v[128:143]
    ds_read_b64_tr_b16 v[44:45], v19 offset:16384
    ds_read_b64_tr_b16 v[46:47], v19 offset:18432
    v_mfma_f32_32x32x16_bf16 v[144:159], v[52:55], v[100:103], v[144:159]
    ds_read_b128 v[108:111], v23
    ds_read_b64_tr_b16 v[48:49], v16 offset:24576
    ds_read_b64_tr_b16 v[50:51], v16 offset:26624
    v_mfma_f32_32x32x16_bf16 v[160:175], v[56:59], v[100:103], v[160:175]
    ds_read_b64_tr_b16 v[52:53], v17 offset:24576
    ds_read_b64_tr_b16 v[54:55], v17 offset:26624
    v_mfma_f32_32x32x16_bf16 v[176:191], v[60:63], v[100:103], v[176:191]
    ds_read_b64_tr_b16 v[56:57], v18 offset:24576
    s_waitcnt lgkmcnt(14)
    ds_read_b64_tr_b16 v[58:59], v18 offset:26624
    s_waitcnt lgkmcnt(7)
    v_mfma_f32_32x32x16_bf16 v[128:143], v[32:35], v[104:107], v[128:143]
    ds_read_b64_tr_b16 v[60:61], v19 offset:24576
    ds_read_b64_tr_b16 v[62:63], v19 offset:26624
    v_mfma_f32_32x32x16_bf16 v[144:159], v[36:39], v[104:107], v[144:159]
    v_add_u32 v16, 40960, v2
    v_xor_b32 v17, 64, v16
    v_xor_b32 v18, 128, v16
    v_xor_b32 v19, 192, v16
    v_mfma_f32_32x32x16_bf16 v[160:175], v[40:43], v[104:107], v[160:175]
    v_add_u32 v20, 40960, v3
    v_xor_b32 v21, 32, v20
    v_xor_b32 v22, 64, v20
    v_xor_b32 v23, 96, v20
    v_mfma_f32_32x32x16_bf16 v[176:191], v[44:47], v[104:107], v[176:191]
    s_waitcnt lgkmcnt(0)
    s_barrier
    ds_read_b128 v[96:99], v20
    ds_read_b64_tr_b16 v[32:33], v16 offset:0
    ds_read_b64_tr_b16 v[34:35], v16 offset:2048
    ds_read_b64_tr_b16 v[36:37], v17 offset:0
    ds_read_b64_tr_b16 v[38:39], v17 offset:2048
    v_mfma_f32_32x32x16_bf16 v[128:143], v[48:51], v[108:111], v[128:143]
    ds_read_b64_tr_b16 v[40:41], v18 offset:0
    ds_read_b64_tr_b16 v[42:43], v18 offset:2048
    v_mfma_f32_32x32x16_bf16 v[144:159], v[52:55], v[108:111], v[144:159]
    ds_read_b64_tr_b16 v[44:45], v19 offset:0
    ds_read_b64_tr_b16 v[46:47], v19 offset:2048
    v_mfma_f32_32x32x16_bf16 v[160:175], v[56:59], v[108:111], v[160:175]
    ds_read_b128 v[100:103], v21
    ds_read_b64_tr_b16 v[48:49], v16 offset:8192
    ds_read_b64_tr_b16 v[50:51], v16 offset:10240
    v_mfma_f32_32x32x16_bf16 v[176:191], v[60:63], v[108:111], v[176:191]
    ds_read_b64_tr_b16 v[52:53], v17 offset:8192
    ds_read_b64_tr_b16 v[54:55], v17 offset:10240
    s_waitcnt lgkmcnt(5)
    v_mfma_f32_32x32x16_bf16 v[128:143], v[32:35], v[96:99], v[128:143]
    ds_read_b64_tr_b16 v[56:57], v18 offset:8192
    ds_read_b64_tr_b16 v[58:59], v18 offset:10240
    v_mfma_f32_32x32x16_bf16 v[144:159], v[36:39], v[96:99], v[144:159]
    ds_read_b64_tr_b16 v[60:61], v19 offset:8192
    ds_read_b64_tr_b16 v[62:63], v19 offset:10240
    v_mfma_f32_32x32x16_bf16 v[160:175], v[40:43], v[96:99], v[160:175]
    ds_read_b128 v[104:107], v22
    ds_read_b64_tr_b16 v[32:33], v16 offset:16384
    ds_read_b64_tr_b16 v[34:35], v16 offset:18432
    ds_read_b64_tr_b16 v[36:37], v17 offset:16384
    ds_read_b64_tr_b16 v[38:39], v17 offset:18432
    v_mfma_f32_32x32x16_bf16 v[176:191], v[44:47], v[96:99], v[176:191]
    ds_read_b64_tr_b16 v[40:41], v18 offset:16384
    s_waitcnt lgkmcnt(14)
    ds_read_b64_tr_b16 v[42:43], v18 offset:18432
    s_waitcnt lgkmcnt(7)
    v_mfma_f32_32x32x16_bf16 v[128:143], v[48:51], v[100:103], v[128:143]
    ds_read_b64_tr_b16 v[44:45], v19 offset:16384
    ds_read_b64_tr_b16 v[46:47], v19 offset:18432
    v_mfma_f32_32x32x16_bf16 v[144:159], v[52:55], v[100:103], v[144:159]
    ds_read_b128 v[108:111], v23
    ds_read_b64_tr_b16 v[48:49], v16 offset:24576
    ds_read_b64_tr_b16 v[50:51], v16 offset:26624
    v_mfma_f32_32x32x16_bf16 v[160:175], v[56:59], v[100:103], v[160:175]
    ds_read_b64_tr_b16 v[52:53], v17 offset:24576
    ds_read_b64_tr_b16 v[54:55], v17 offset:26624
    v_mfma_f32_32x32x16_bf16 v[176:191], v[60:63], v[100:103], v[176:191]
    ds_read_b64_tr_b16 v[56:57], v18 offset:24576
    s_waitcnt lgkmcnt(14)
    ds_read_b64_tr_b16 v[58:59], v18 offset:26624
    s_waitcnt lgkmcnt(7)
    v_mfma_f32_32x32x16_bf16 v[128:143], v[32:35], v[104:107], v[128:143]
    ds_read_b64_tr_b16 v[60:61], v19 offset:24576
    ds_read_b64_tr_b16 v[62:63], v19 offset:26624
    v_mfma_f32_32x32x16_bf16 v[144:159], v[36:39], v[104:107], v[144:159]
    v_add_u32 v16, 81920, v2
    v_xor_b32 v17, 64, v16
    v_xor_b32 v18, 128, v16
    v_xor_b32 v19, 192, v16
    v_mfma_f32_32x32x16_bf16 v[160:175], v[40:43], v[104:107], v[160:175]
    v_add_u32 v20, 81920, v3
    v_xor_b32 v21, 32, v20
    v_xor_b32 v22, 64, v20
    v_xor_b32 v23, 96, v20
    v_mfma_f32_32x32x16_bf16 v[176:191], v[44:47], v[104:107], v[176:191]
    s_waitcnt lgkmcnt(0)
    s_barrier
    ds_read_b128 v[96:99], v20
    ds_read_b64_tr_b16 v[32:33], v16 offset:0
    ds_read_b64_tr_b16 v[34:35], v16 offset:2048
    ds_read_b64_tr_b16 v[36:37], v17 offset:0
    ds_read_b64_tr_b16 v[38:39], v17 offset:2048
    v_mfma_f32_32x32x16_bf16 v[128:143], v[48:51], v[108:111], v[128:143]
    ds_read_b64_tr_b16 v[40:41], v18 offset:0
    ds_read_b64_tr_b16 v[42:43], v18 offset:2048
    v_mfma_f32_32x32x16_bf16 v[144:159], v[52:55], v[108:111], v[144:159]
    ds_read_b64_tr_b16 v[44:45], v19 offset:0
    ds_read_b64_tr_b16 v[46:47], v19 offset:2048
    v_mfma_f32_32x32x16_bf16 v[160:175], v[56:59], v[108:111], v[160:175]
    ds_read_b128 v[100:103], v21
    ds_read_b64_tr_b16 v[48:49], v16 offset:8192
    ds_read_b64_tr_b16 v[50:51], v16 offset:10240
    v_mfma_f32_32x32x16_bf16 v[176:191], v[60:63], v[108:111], v[176:191]
    ds_read_b64_tr_b16 v[52:53], v17 offset:8192
    ds_read_b64_tr_b16 v[54:55], v17 offset:10240
    s_waitcnt lgkmcnt(5)
    v_mfma_f32_32x32x16_bf16 v[128:143], v[32:35], v[96:99], v[128:143]
    ds_read_b64_tr_b16 v[56:57], v18 offset:8192
    ds_read_b64_tr_b16 v[58:59], v18 offset:10240
    v_mfma_f32_32x32x16_bf16 v[144:159], v[36:39], v[96:99], v[144:159]
    ds_read_b64_tr_b16 v[60:61], v19 offset:8192
    ds_read_b64_tr_b16 v[62:63], v19 offset:10240
    v_mfma_f32_32x32x16_bf16 v[160:175], v[40:43], v[96:99], v[160:175]
    ds_read_b128 v[104:107], v22
    ds_read_b64_tr_b16 v[32:33], v16 offset:16384
    ds_read_b64_tr_b16 v[34:35], v16 offset:18432
    ds_read_b64_tr_b16 v[36:37], v17 offset:16384
    ds_read_b64_tr_b16 v[38:39], v17 offset:18432
    v_mfma_f32_32x32x16_bf16 v[176:191], v[44:47], v[96:99], v[176:191]
    ds_read_b64_tr_b16 v[40:41], v18 offset:16384
    s_waitcnt lgkmcnt(14)
    ds_read_b64_tr_b16 v[42:43], v18 offset:18432
    s_waitcnt lgkmcnt(7)
    v_mfma_f32_32x32x16_bf16 v[128:143], v[48:51], v[100:103], v[128:143]
    ds_read_b64_tr_b16 v[44:45], v19 offset:16384
    ds_read_b64_tr_b16 v[46:47], v19 offset:18432
    v_mfma_f32_32x32x16_bf16 v[144:159], v[52:55], v[100:103], v[144:159]
    ds_read_b128 v[108:111], v23
    ds_read_b64_tr_b16 v[48:49], v16 offset:24576
    ds_read_b64_tr_b16 v[50:51], v16 offset:26624
    v_mfma_f32_32x32x16_bf16 v[160:175], v[56:59], v[100:103], v[160:175]
    ds_read_b64_tr_b16 v[52:53], v17 offset:24576
    ds_read_b64_tr_b16 v[54:55], v17 offset:26624
    v_mfma_f32_32x32x16_bf16 v[176:191], v[60:63], v[100:103], v[176:191]
    ds_read_b64_tr_b16 v[56:57], v18 offset:24576
    s_waitcnt lgkmcnt(14)
    ds_read_b64_tr_b16 v[58:59], v18 offset:26624
    s_waitcnt lgkmcnt(7)
    v_mfma_f32_32x32x16_bf16 v[128:143], v[32:35], v[104:107], v[128:143]
    ds_read_b64_tr_b16 v[60:61], v19 offset:24576
    ds_read_b64_tr_b16 v[62:63], v19 offset:26624
    v_mfma_f32_32x32x16_bf16 v[144:159], v[36:39], v[104:107], v[144:159]
    v_add_u32 v16, 122880, v2
    v_xor_b32 v17, 64, v16
    v_xor_b32 v18, 128, v16
    v_xor_b32 v19, 192, v16
    v_mfma_f32_32x32x16_bf16 v[160:175], v[40:43], v[104:107], v[160:175]
    v_add_u32 v20, 122880, v3
    v_xor_b32 v21, 32, v20
    v_xor_b32 v22, 64, v20
    v_xor_b32 v23, 96, v20
    v_mfma_f32_32x32x16_bf16 v[176:191], v[44:47], v[104:107], v[176:191]
    s_waitcnt lgkmcnt(0)
    s_barrier
    ds_read_b128 v[96:99], v20
    ds_read_b64_tr_b16 v[32:33], v16 offset:0
    ds_read_b64_tr_b16 v[34:35], v16 offset:2048
    ds_read_b64_tr_b16 v[36:37], v17 offset:0
    ds_read_b64_tr_b16 v[38:39], v17 offset:2048
    v_mfma_f32_32x32x16_bf16 v[128:143], v[48:51], v[108:111], v[128:143]
    ds_read_b64_tr_b16 v[40:41], v18 offset:0
    ds_read_b64_tr_b16 v[42:43], v18 offset:2048
    v_mfma_f32_32x32x16_bf16 v[144:159], v[52:55], v[108:111], v[144:159]
    ds_read_b64_tr_b16 v[44:45], v19 offset:0
    ds_read_b64_tr_b16 v[46:47], v19 offset:2048
    v_mfma_f32_32x32x16_bf16 v[160:175], v[56:59], v[108:111], v[160:175]
    ds_read_b128 v[100:103], v21
    ds_read_b64_tr_b16 v[48:49], v16 offset:8192
    ds_read_b64_tr_b16 v[50:51], v16 offset:10240
    v_mfma_f32_32x32x16_bf16 v[176:191], v[60:63], v[108:111], v[176:191]
    ds_read_b64_tr_b16 v[52:53], v17 offset:8192
    ds_read_b64_tr_b16 v[54:55], v17 offset:10240
    s_waitcnt lgkmcnt(5)
    v_mfma_f32_32x32x16_bf16 v[128:143], v[32:35], v[96:99], v[128:143]
    ds_read_b64_tr_b16 v[56:57], v18 offset:8192
    ds_read_b64_tr_b16 v[58:59], v18 offset:10240
    v_mfma_f32_32x32x16_bf16 v[144:159], v[36:39], v[96:99], v[144:159]
    ds_read_b64_tr_b16 v[60:61], v19 offset:8192
    ds_read_b64_tr_b16 v[62:63], v19 offset:10240
    v_mfma_f32_32x32x16_bf16 v[160:175], v[40:43], v[96:99], v[160:175]
    ds_read_b128 v[104:107], v22
    ds_read_b64_tr_b16 v[32:33], v16 offset:16384
    ds_read_b64_tr_b16 v[34:35], v16 offset:18432
    ds_read_b64_tr_b16 v[36:37], v17 offset:16384
    ds_read_b64_tr_b16 v[38:39], v17 offset:18432
    v_mfma_f32_32x32x16_bf16 v[176:191], v[44:47], v[96:99], v[176:191]
    ds_read_b64_tr_b16 v[40:41], v18 offset:16384
    s_waitcnt lgkmcnt(14)
    ds_read_b64_tr_b16 v[42:43], v18 offset:18432
    s_waitcnt lgkmcnt(7)
    v_mfma_f32_32x32x16_bf16 v[128:143], v[48:51], v[100:103], v[128:143]
    ds_read_b64_tr_b16 v[44:45], v19 offset:16384
    ds_read_b64_tr_b16 v[46:47], v19 offset:18432
    v_mfma_f32_32x32x16_bf16 v[144:159], v[52:55], v[100:103], v[144:159]
    ds_read_b128 v[108:111], v23
    ds_read_b64_tr_b16 v[48:49], v16 offset:24576
    ds_read_b64_tr_b16 v[50:51], v16 offset:26624
    v_mfma_f32_32x32x16_bf16 v[160:175], v[56:59], v[100:103], v[160:175]
    ds_read_b64_tr_b16 v[52:53], v17 offset:24576
    ds_read_b64_tr_b16 v[54:55], v17 offset:26624
    v_mfma_f32_32x32x16_bf16 v[176:191], v[60:63], v[100:103], v[176:191]
    ds_read_b64_tr_b16 v[56:57], v18 offset:24576
    s_waitcnt lgkmcnt(14)
    ds_read_b64_tr_b16 v[58:59], v18 offset:26624
    s_waitcnt lgkmcnt(7)
    v_mfma_f32_32x32x16_bf16 v[128:143], v[32:35], v[104:107], v[128:143]
    ds_read_b64_tr_b16 v[60:61], v19 offset:24576
    ds_read_b64_tr_b16 v[62:63], v19 offset:26624
    v_mfma_f32_32x32x16_bf16 v[144:159], v[36:39], v[104:107], v[144:159]
    v_mov_b32 v16, v2
    v_xor_b32 v17, 64, v16
    v_xor_b32 v18, 128, v16
    v_xor_b32 v19, 192, v16
    v_mfma_f32_32x32x16_bf16 v[160:175], v[40:43], v[104:107], v[160:175]
    v_mov_b32 v20, v3
    v_xor_b32 v21, 32, v20
    v_xor_b32 v22, 64, v20
    v_xor_b32 v23, 96, v20
    v_mfma_f32_32x32x16_bf16 v[176:191], v[44:47], v[104:107], v[176:191]
    s_waitcnt lgkmcnt(0)
    s_barrier
    ds_read_b128 v[96:99], v20
    ds_read_b64_tr_b16 v[32:33], v16 offset:0
    ds_read_b64_tr_b16 v[34:35], v16 offset:2048
    ds_read_b64_tr_b16 v[36:37], v17 offset:0
    ds_read_b64_tr_b16 v[38:39], v17 offset:2048
    v_mfma_f32_32x32x16_bf16 v[128:143], v[48:51], v[108:111], v[128:143]
    ds_read_b64_tr_b16 v[40:41], v18 offset:0
    ds_read_b64_tr_b16 v[42:43], v18 offset:2048
    v_mfma_f32_32x32x16_bf16 v[144:159], v[52:55], v[108:111], v[144:159]
    ds_read_b64_tr_b16 v[44:45], v19 offset:0
    ds_read_b64_tr_b16 v[46:47], v19 offset:2048
    v_mfma_f32_32x32x16_bf16 v[160:175], v[56:59], v[108:111], v[160:175]
    ds_read_b128 v[100:103], v21
    ds_read_b64_tr_b16 v[48:49], v16 offset:8192
    ds_read_b64_tr_b16 v[50:51], v16 offset:10240
    v_mfma_f32_32x32x16_bf16 v[176:191], v[60:63], v[108:111], v[176:191]
    ds_read_b64_tr_b16 v[52:53], v17 offset:8192
    ds_read_b64_tr_b16 v[54:55], v17 offset:10240
    s_waitcnt lgkmcnt(5)
    v_mfma_f32_32x32x16_bf16 v[128:143], v[32:35], v[96:99], v[128:143]
    ds_read_b64_tr_b16 v[56:57], v18 offset:8192
    ds_read_b64_tr_b16 v[58:59], v18 offset:10240
    v_mfma_f32_32x32x16_bf16 v[144:159], v[36:39], v[96:99], v[144:159]
    ds_read_b64_tr_b16 v[60:61], v19 offset:8192
    ds_read_b64_tr_b16 v[62:63], v19 offset:10240
    v_mfma_f32_32x32x16_bf16 v[160:175], v[40:43], v[96:99], v[160:175]
    ds_read_b128 v[104:107], v22
    ds_read_b64_tr_b16 v[32:33], v16 offset:16384
    ds_read_b64_tr_b16 v[34:35], v16 offset:18432
    ds_read_b64_tr_b16 v[36:37], v17 offset:16384
    ds_read_b64_tr_b16 v[38:39], v17 offset:18432
    v_mfma_f32_32x32x16_bf16 v[176:191], v[44:47], v[96:99], v[176:191]
    ds_read_b64_tr_b16 v[40:41], v18 offset:16384
    s_waitcnt lgkmcnt(14)
    ds_read_b64_tr_b16 v[42:43], v18 offset:18432
    s_waitcnt lgkmcnt(7)
    v_mfma_f32_32x32x16_bf16 v[128:143], v[48:51], v[100:103], v[128:143]
    ds_read_b64_tr_b16 v[44:45], v19 offset:16384
    ds_read_b64_tr_b16 v[46:47], v19 offset:18432
    v_mfma_f32_32x32x16_bf16 v[144:159], v[52:55], v[100:103], v[144:159]
    ds_read_b128 v[108:111], v23
    ds_read_b64_tr_b16 v[48:49], v16 offset:24576
    ds_read_b64_tr_b16 v[50:51], v16 offset:26624
    v_mfma_f32_32x32x16_bf16 v[160:175], v[56:59], v[100:103], v[160:175]
    ds_read_b64_tr_b16 v[52:53], v17 offset:24576
    ds_read_b64_tr_b16 v[54:55], v17 offset:26624
    v_mfma_f32_32x32x16_bf16 v[176:191], v[60:63], v[100:103], v[176:191]
    ds_read_b64_tr_b16 v[56:57], v18 offset:24576
    s_waitcnt lgkmcnt(14)
    ds_read_b64_tr_b16 v[58:59], v18 offset:26624
    s_waitcnt lgkmcnt(7)
    v_mfma_f32_32x32x16_bf16 v[128:143], v[32:35], v[104:107], v[128:143]
    ds_read_b64_tr_b16 v[60:61], v19 offset:24576
    ds_read_b64_tr_b16 v[62:63], v19 offset:26624
    v_mfma_f32_32x32x16_bf16 v[144:159], v[36:39], v[104:107], v[144:159]
    v_add_u32 v16, 40960, v2
    v_xor_b32 v17, 64, v16
    v_xor_b32 v18, 128, v16
    v_xor_b32 v19, 192, v16
    v_mfma_f32_32x32x16_bf16 v[160:175], v[40:43], v[104:107], v[160:175]
    v_add_u32 v20, 40960, v3
    v_xor_b32 v21, 32, v20
    v_xor_b32 v22, 64, v20
    v_xor_b32 v23, 96, v20
    v_mfma_f32_32x32x16_bf16 v[176:191], v[44:47], v[104:107], v[176:191]
    s_waitcnt lgkmcnt(0)
    s_barrier
    ds_read_b128 v[96:99], v20
    ds_read_b64_tr_b16 v[32:33], v16 offset:0
    ds_read_b64_tr_b16 v[34:35], v16 offset:2048
    ds_read_b64_tr_b16 v[36:37], v17 offset:0
    ds_read_b64_tr_b16 v[38:39], v17 offset:2048
    v_mfma_f32_32x32x16_bf16 v[128:143], v[48:51], v[108:111], v[128:143]
    ds_read_b64_tr_b16 v[40:41], v18 offset:0
    ds_read_b64_tr_b16 v[42:43], v18 offset:2048
    v_mfma_f32_32x32x16_bf16 v[144:159], v[52:55], v[108:111], v[144:159]
    ds_read_b64_tr_b16 v[44:45], v19 offset:0
    ds_read_b64_tr_b16 v[46:47], v19 offset:2048
    v_mfma_f32_32x32x16_bf16 v[160:175], v[56:59], v[108:111], v[160:175]
    ds_read_b128 v[100:103], v21
    ds_read_b64_tr_b16 v[48:49], v16 offset:8192
    ds_read_b64_tr_b16 v[50:51], v16 offset:10240
    v_mfma_f32_32x32x16_bf16 v[176:191], v[60:63], v[108:111], v[176:191]
    ds_read_b64_tr_b16 v[52:53], v17 offset:8192
    ds_read_b64_tr_b16 v[54:55], v17 offset:10240
    s_waitcnt lgkmcnt(5)
    v_mfma_f32_32x32x16_bf16 v[128:143], v[32:35], v[96:99], v[128:143]
    ds_read_b64_tr_b16 v[56:57], v18 offset:8192
    ds_read_b64_tr_b16 v[58:59], v18 offset:10240
    v_mfma_f32_32x32x16_bf16 v[144:159], v[36:39], v[96:99], v[144:159]
    ds_read_b64_tr_b16 v[60:61], v19 offset:8192
    ds_read_b64_tr_b16 v[62:63], v19 offset:10240
    v_mfma_f32_32x32x16_bf16 v[160:175], v[40:43], v[96:99], v[160:175]
    ds_read_b128 v[104:107], v22
    ds_read_b64_tr_b16 v[32:33], v16 offset:16384
    ds_read_b64_tr_b16 v[34:35], v16 offset:18432
    ds_read_b64_tr_b16 v[36:37], v17 offset:16384
    ds_read_b64_tr_b16 v[38:39], v17 offset:18432
    v_mfma_f32_32x32x16_bf16 v[176:191], v[44:47], v[96:99], v[176:191]
    ds_read_b64_tr_b16 v[40:41], v18 offset:16384
    s_waitcnt lgkmcnt(14)
    ds_read_b64_tr_b16 v[42:43], v18 offset:18432
    s_waitcnt lgkmcnt(7)
    v_mfma_f32_32x32x16_bf16 v[128:143], v[48:51], v[100:103], v[128:143]
    ds_read_b64_tr_b16 v[44:45], v19 offset:16384
    ds_read_b64_tr_b16 v[46:47], v19 offset:18432
    v_mfma_f32_32x32x16_bf16 v[144:159], v[52:55], v[100:103], v[144:159]
    ds_read_b128 v[108:111], v23
    ds_read_b64_tr_b16 v[48:49], v16 offset:24576
    ds_read_b64_tr_b16 v[50:51], v16 offset:26624
    v_mfma_f32_32x32x16_bf16 v[160:175], v[56:59], v[100:103], v[160:175]
    ds_read_b64_tr_b16 v[52:53], v17 offset:24576
    ds_read_b64_tr_b16 v[54:55], v17 offset:26624
    v_mfma_f32_32x32x16_bf16 v[176:191], v[60:63], v[100:103], v[176:191]
    ds_read_b64_tr_b16 v[56:57], v18 offset:24576
    s_waitcnt lgkmcnt(14)
    ds_read_b64_tr_b16 v[58:59], v18 offset:26624
    s_waitcnt lgkmcnt(7)
    v_mfma_f32_32x32x16_bf16 v[128:143], v[32:35], v[104:107], v[128:143]
    ds_read_b64_tr_b16 v[60:61], v19 offset:24576
    ds_read_b64_tr_b16 v[62:63], v19 offset:26624
    v_mfma_f32_32x32x16_bf16 v[144:159], v[36:39], v[104:107], v[144:159]
    v_add_u32 v16, 81920, v2
    v_xor_b32 v17, 64, v16
    v_xor_b32 v18, 128, v16
    v_xor_b32 v19, 192, v16
    v_mfma_f32_32x32x16_bf16 v[160:175], v[40:43], v[104:107], v[160:175]
    v_add_u32 v20, 81920, v3
    v_xor_b32 v21, 32, v20
    v_xor_b32 v22, 64, v20
    v_xor_b32 v23, 96, v20
    v_mfma_f32_32x32x16_bf16 v[176:191], v[44:47], v[104:107], v[176:191]
    s_waitcnt lgkmcnt(0)
    s_barrier
    ds_read_b128 v[96:99], v20
    ds_read_b64_tr_b16 v[32:33], v16 offset:0
    ds_read_b64_tr_b16 v[34:35], v16 offset:2048
    ds_read_b64_tr_b16 v[36:37], v17 offset:0
    ds_read_b64_tr_b16 v[38:39], v17 offset:2048
    v_mfma_f32_32x32x16_bf16 v[128:143], v[48:51], v[108:111], v[128:143]
    ds_read_b64_tr_b16 v[40:41], v18 offset:0
    ds_read_b64_tr_b16 v[42:43], v18 offset:2048
    v_mfma_f32_32x32x16_bf16 v[144:159], v[52:55], v[108:111], v[144:159]
    ds_read_b64_tr_b16 v[44:45], v19 offset:0
    ds_read_b64_tr_b16 v[46:47], v19 offset:2048
    v_mfma_f32_32x32x16_bf16 v[160:175], v[56:59], v[108:111], v[160:175]
    ds_read_b128 v[100:103], v21
    ds_read_b64_tr_b16 v[48:49], v16 offset:8192
    ds_read_b64_tr_b16 v[50:51], v16 offset:10240
    v_mfma_f32_32x32x16_bf16 v[176:191], v[60:63], v[108:111], v[176:191]
    ds_read_b64_tr_b16 v[52:53], v17 offset:8192
    ds_read_b64_tr_b16 v[54:55], v17 offset:10240
    s_waitcnt lgkmcnt(5)
    v_mfma_f32_32x32x16_bf16 v[128:143], v[32:35], v[96:99], v[128:143]
    ds_read_b64_tr_b16 v[56:57], v18 offset:8192
    ds_read_b64_tr_b16 v[58:59], v18 offset:10240
    v_mfma_f32_32x32x16_bf16 v[144:159], v[36:39], v[96:99], v[144:159]
    ds_read_b64_tr_b16 v[60:61], v19 offset:8192
    ds_read_b64_tr_b16 v[62:63], v19 offset:10240
    v_mfma_f32_32x32x16_bf16 v[160:175], v[40:43], v[96:99], v[160:175]
    ds_read_b128 v[104:107], v22
    ds_read_b64_tr_b16 v[32:33], v16 offset:16384
    ds_read_b64_tr_b16 v[34:35], v16 offset:18432
    ds_read_b64_tr_b16 v[36:37], v17 offset:16384
    ds_read_b64_tr_b16 v[38:39], v17 offset:18432
    v_mfma_f32_32x32x16_bf16 v[176:191], v[44:47], v[96:99], v[176:191]
    ds_read_b64_tr_b16 v[40:41], v18 offset:16384
    s_waitcnt lgkmcnt(14)
    ds_read_b64_tr_b16 v[42:43], v18 offset:18432
    s_waitcnt lgkmcnt(7)
    v_mfma_f32_32x32x16_bf16 v[128:143], v[48:51], v[100:103], v[128:143]
    ds_read_b64_tr_b16 v[44:45], v19 offset:16384
    ds_read_b64_tr_b16 v[46:47], v19 offset:18432
    v_mfma_f32_32x32x16_bf16 v[144:159], v[52:55], v[100:103], v[144:159]
    ds_read_b128 v[108:111], v23
    ds_read_b64_tr_b16 v[48:49], v16 offset:24576
    ds_read_b64_tr_b16 v[50:51], v16 offset:26624
    v_mfma_f32_32x32x16_bf16 v[160:175], v[56:59], v[100:103], v[160:175]
    ds_read_b64_tr_b16 v[52:53], v17 offset:24576
    ds_read_b64_tr_b16 v[54:55], v17 offset:26624
    v_mfma_f32_32x32x16_bf16 v[176:191], v[60:63], v[100:103], v[176:191]
    ds_read_b64_tr_b16 v[56:57], v18 offset:24576
    s_waitcnt lgkmcnt(14)
    ds_read_b64_tr_b16 v[58:59], v18 offset:26624
    s_waitcnt lgkmcnt(7)
    v_mfma_f32_32x32x16_bf16 v[128:143], v[32:35], v[104:107], v[128:143]
    ds_read_b64_tr_b16 v[60:61], v19 offset:24576
    ds_read_b64_tr_b16 v[62:63], v19 offset:26624
    v_mfma_f32_32x32x16_bf16 v[144:159], v[36:39], v[104:107], v[144:159]
    v_add_u32 v16, 122880, v2
    v_xor_b32 v17, 64, v16
    v_xor_b32 v18, 128, v16
    v_xor_b32 v19, 192, v16
    v_mfma_f32_32x32x16_bf16 v[160:175], v[40:43], v[104:107], v[160:175]
    v_add_u32 v20, 122880, v3
    v_xor_b32 v21, 32, v20
    v_xor_b32 v22, 64, v20
    v_xor_b32 v23, 96, v20
    v_mfma_f32_32x32x16_bf16 v[176:191], v[44:47], v[104:107], v[176:191]
    s_waitcnt lgkmcnt(0)
    s_barrier
    ds_read_b128 v[112:115], v20
    ds_read_b64_tr_b16 v[32:33], v16 offset:0
    ds_read_b64_tr_b16 v[34:35], v16 offset:2048
    ds_read_b128 v[116:119], v21
    ds_read_b64_tr_b16 v[36:37], v16 offset:8192
    ds_read_b64_tr_b16 v[38:39], v16 offset:10240
    v_mfma_f32_32x32x16_bf16 v[128:143], v[48:51], v[108:111], v[128:143]
    ds_read_b128 v[120:123], v22
    ds_read_b64_tr_b16 v[40:41], v16 offset:16384
    ds_read_b64_tr_b16 v[42:43], v16 offset:18432
    v_mfma_f32_32x32x16_bf16 v[144:159], v[52:55], v[108:111], v[144:159]
    ds_read_b128 v[124:127], v23
    ds_read_b64_tr_b16 v[44:45], v16 offset:24576
    ds_read_b64_tr_b16 v[46:47], v16 offset:26624
    v_mfma_f32_32x32x16_bf16 v[160:175], v[56:59], v[108:111], v[160:175]
    ds_read_b64_tr_b16 v[48:49], v17 offset:0
    ds_read_b64_tr_b16 v[50:51], v17 offset:2048
    v_mfma_f32_32x32x16_bf16 v[176:191], v[60:63], v[108:111], v[176:191]
    ds_read_b64_tr_b16 v[52:53], v17 offset:8192
    s_waitcnt lgkmcnt(14)
    ds_read_b64_tr_b16 v[54:55], v17 offset:10240
    s_waitcnt lgkmcnt(4)
    v_mfma_f32_32x32x16_bf16 v[128:143], v[32:35], v[112:115], v[128:143]
    ds_read_b64_tr_b16 v[56:57], v17 offset:16384
    ds_read_b64_tr_b16 v[58:59], v17 offset:18432
    v_mfma_f32_32x32x16_bf16 v[128:143], v[36:39], v[116:119], v[128:143]
    ds_read_b64_tr_b16 v[60:61], v17 offset:24576
    ds_read_b64_tr_b16 v[62:63], v17 offset:26624
    v_mfma_f32_32x32x16_bf16 v[128:143], v[40:43], v[120:123], v[128:143]
    ds_read_b64_tr_b16 v[32:33], v18 offset:0
    ds_read_b64_tr_b16 v[34:35], v18 offset:2048
    ds_read_b64_tr_b16 v[36:37], v18 offset:8192
    ds_read_b64_tr_b16 v[38:39], v18 offset:10240
    v_mfma_f32_32x32x16_bf16 v[128:143], v[44:47], v[124:127], v[128:143]
    ds_read_b64_tr_b16 v[40:41], v18 offset:16384
    ds_read_b64_tr_b16 v[42:43], v18 offset:18432
    s_waitcnt lgkmcnt(6)
    v_mfma_f32_32x32x16_bf16 v[144:159], v[48:51], v[112:115], v[144:159]
    ds_read_b64_tr_b16 v[44:45], v18 offset:24576
    ds_read_b64_tr_b16 v[46:47], v18 offset:26624
    v_mfma_f32_32x32x16_bf16 v[144:159], v[52:55], v[116:119], v[144:159]
    ds_read_b64_tr_b16 v[48:49], v19 offset:0
    ds_read_b64_tr_b16 v[50:51], v19 offset:2048
    v_mfma_f32_32x32x16_bf16 v[144:159], v[56:59], v[120:123], v[144:159]
    ds_read_b64_tr_b16 v[52:53], v19 offset:8192
    ds_read_b64_tr_b16 v[54:55], v19 offset:10240
    v_mul_f32 v128, s72, v128
    v_mul_f32 v129, s72, v129
    v_cvt_pk_bf16_f32 v64, v128, v129
    v_mul_f32 v130, s72, v130
    v_mul_f32 v131, s72, v131
    v_cvt_pk_bf16_f32 v65, v130, v131
    v_mul_f32 v132, s72, v132
    v_mul_f32 v133, s72, v133
    v_mfma_f32_32x32x16_bf16 v[144:159], v[60:63], v[124:127], v[144:159]
    ds_read_b64_tr_b16 v[56:57], v19 offset:16384
    ds_read_b64_tr_b16 v[58:59], v19 offset:18432
    v_cvt_pk_bf16_f32 v66, v132, v133
    v_mul_f32 v134, s72, v134
    v_mul_f32 v135, s72, v135
    v_cvt_pk_bf16_f32 v67, v134, v135
    v_mul_f32 v136, s72, v136
    v_mul_f32 v137, s72, v137
    v_cvt_pk_bf16_f32 v68, v136, v137
    v_mul_f32 v138, s72, v138
    s_waitcnt lgkmcnt(6)
    v_mfma_f32_32x32x16_bf16 v[160:175], v[32:35], v[112:115], v[160:175]
    ds_read_b64_tr_b16 v[60:61], v19 offset:24576
    ds_read_b64_tr_b16 v[62:63], v19 offset:26624
    v_mul_f32 v139, s72, v139
    v_cvt_pk_bf16_f32 v69, v138, v139
    v_mul_f32 v140, s72, v140
    v_mul_f32 v141, s72, v141
    v_cvt_pk_bf16_f32 v70, v140, v141
    v_mul_f32 v142, s72, v142
    v_mul_f32 v143, s72, v143
    v_cvt_pk_bf16_f32 v71, v142, v143
    v_mfma_f32_32x32x16_bf16 v[160:175], v[36:39], v[116:119], v[160:175]
    v_mov_b32 v16, v1
    v_xor_b32 v17, 32, v16
    v_xor_b32 v18, 64, v16
    v_xor_b32 v19, 96, v16
    v_mfma_f32_32x32x16_bf16 v[160:175], v[40:43], v[120:123], v[160:175]
    v_xor_b32 v20, 128, v16
    v_xor_b32 v21, 160, v16
    v_xor_b32 v22, 192, v16
    v_xor_b32 v23, 224, v16
    v_mul_f32 v144, s72, v144
    v_mul_f32 v145, s72, v145
    v_cvt_pk_bf16_f32 v72, v144, v145
    v_mul_f32 v146, s72, v146
    v_mul_f32 v147, s72, v147
    v_cvt_pk_bf16_f32 v73, v146, v147
    v_mul_f32 v148, s72, v148
    v_mul_f32 v149, s72, v149
    v_mfma_f32_32x32x16_bf16 v[160:175], v[44:47], v[124:127], v[160:175]
    s_waitcnt lgkmcnt(0)
    s_barrier
    ds_read_b128 v[32:35], v16 offset:0
    ds_read_b128 v[36:39], v17 offset:0
    v_cvt_pk_bf16_f32 v74, v148, v149
    v_mul_f32 v150, s72, v150
    v_mul_f32 v151, s72, v151
    v_cvt_pk_bf16_f32 v75, v150, v151
    v_mul_f32 v152, s72, v152
    v_mul_f32 v153, s72, v153
    v_cvt_pk_bf16_f32 v76, v152, v153
    v_mul_f32 v154, s72, v154
    v_mfma_f32_32x32x16_bf16 v[176:191], v[48:51], v[112:115], v[176:191]
    ds_read_b128 v[40:43], v18 offset:0
    v_mul_f32 v155, s72, v155
    v_cvt_pk_bf16_f32 v77, v154, v155
    v_mul_f32 v156, s72, v156
    v_mul_f32 v157, s72, v157
    v_cvt_pk_bf16_f32 v78, v156, v157
    v_mul_f32 v158, s72, v158
    v_mul_f32 v159, s72, v159
    v_cvt_pk_bf16_f32 v79, v158, v159
    v_mfma_f32_32x32x16_bf16 v[176:191], v[52:55], v[116:119], v[176:191]
    ds_read_b128 v[44:47], v19 offset:0
    v_mfma_f32_32x32x16_bf16 v[176:191], v[56:59], v[120:123], v[176:191]
    ds_read_b128 v[48:51], v20 offset:0
    v_mul_f32 v160, s72, v160
    v_mul_f32 v161, s72, v161
    v_cvt_pk_bf16_f32 v80, v160, v161
    v_mul_f32 v162, s72, v162
    v_mul_f32 v163, s72, v163
    v_cvt_pk_bf16_f32 v81, v162, v163
    v_mul_f32 v164, s72, v164
    v_mul_f32 v165, s72, v165
    v_mfma_f32_32x32x16_bf16 v[176:191], v[60:63], v[124:127], v[176:191]
    ds_read_b128 v[52:55], v21 offset:0
    v_cvt_pk_bf16_f32 v82, v164, v165
    v_mul_f32 v166, s72, v166
    v_mul_f32 v167, s72, v167
    v_cvt_pk_bf16_f32 v83, v166, v167
    v_mul_f32 v168, s72, v168
    v_mul_f32 v169, s72, v169
    v_cvt_pk_bf16_f32 v84, v168, v169
    v_mul_f32 v170, s72, v170
    s_waitcnt lgkmcnt(2)
    v_mfma_f32_32x32x16_bf16 v[192:207], v[32:35], v[64:67], 0
    ds_read_b128 v[56:59], v22 offset:0
    v_mul_f32 v171, s72, v171
    v_cvt_pk_bf16_f32 v85, v170, v171
    v_mul_f32 v172, s72, v172
    v_mul_f32 v173, s72, v173
    v_cvt_pk_bf16_f32 v86, v172, v173
    v_mul_f32 v174, s72, v174
    v_mul_f32 v175, s72, v175
    v_cvt_pk_bf16_f32 v87, v174, v175
    v_mfma_f32_32x32x16_bf16 v[192:207], v[36:39], v[68:71], v[192:207]
    ds_read_b128 v[60:63], v23 offset:0
    v_mfma_f32_32x32x16_bf16 v[192:207], v[40:43], v[72:75], v[192:207]
    ds_read_b128 v[32:35], v16 offset:8192
    ds_read_b128 v[36:39], v17 offset:8192
    v_mul_f32 v176, s72, v176
    v_mul_f32 v177, s72, v177
    v_cvt_pk_bf16_f32 v88, v176, v177
    v_mul_f32 v178, s72, v178
    v_mul_f32 v179, s72, v179
    v_cvt_pk_bf16_f32 v89, v178, v179
    v_mul_f32 v180, s72, v180
    v_mul_f32 v181, s72, v181
    v_mfma_f32_32x32x16_bf16 v[192:207], v[44:47], v[76:79], v[192:207]
    ds_read_b128 v[40:43], v18 offset:8192
    v_cvt_pk_bf16_f32 v90, v180, v181
    v_mul_f32 v182, s72, v182
    v_mul_f32 v183, s72, v183
    v_cvt_pk_bf16_f32 v91, v182, v183
    v_mul_f32 v184, s72, v184
    v_mul_f32 v185, s72, v185
    v_cvt_pk_bf16_f32 v92, v184, v185
    v_mul_f32 v186, s72, v186
    s_waitcnt lgkmcnt(3)
    v_mfma_f32_32x32x16_bf16 v[192:207], v[48:51], v[80:83], v[192:207]
    ds_read_b128 v[44:47], v19 offset:8192
    v_mul_f32 v187, s72, v187
    v_cvt_pk_bf16_f32 v93, v186, v187
    v_mul_f32 v188, s72, v188
    v_mul_f32 v189, s72, v189
    v_cvt_pk_bf16_f32 v94, v188, v189
    v_mul_f32 v190, s72, v190
    v_mul_f32 v191, s72, v191
    v_cvt_pk_bf16_f32 v95, v190, v191
    v_mfma_f32_32x32x16_bf16 v[192:207], v[52:55], v[84:87], v[192:207]
    ds_read_b128 v[48:51], v20 offset:8192
    v_mfma_f32_32x32x16_bf16 v[192:207], v[56:59], v[88:91], v[192:207]
    ds_read_b128 v[52:55], v21 offset:8192
    v_mfma_f32_32x32x16_bf16 v[192:207], v[60:63], v[92:95], v[192:207]
    ds_read_b128 v[56:59], v22 offset:8192
    s_waitcnt lgkmcnt(3)
    v_mfma_f32_32x32x16_bf16 v[208:223], v[32:35], v[64:67], 0
    ds_read_b128 v[60:63], v23 offset:8192
    v_mfma_f32_32x32x16_bf16 v[208:223], v[36:39], v[68:71], v[208:223]
    v_add_u32 v16, 32768, v1
    v_xor_b32 v17, 32, v16
    v_xor_b32 v18, 64, v16
    v_xor_b32 v19, 96, v16
    v_mfma_f32_32x32x16_bf16 v[208:223], v[40:43], v[72:75], v[208:223]
    v_xor_b32 v20, 128, v16
    v_xor_b32 v21, 160, v16
    v_xor_b32 v22, 192, v16
    v_xor_b32 v23, 224, v16
    v_max3_f32 v15, v192, v193, v15
    v_max3_f32 v15, v194, v195, v15
    v_mfma_f32_32x32x16_bf16 v[208:223], v[44:47], v[76:79], v[208:223]
    s_waitcnt lgkmcnt(0)
    s_barrier
    ds_read_b128 v[32:35], v16 offset:0
    ds_read_b128 v[36:39], v17 offset:0
    v_max3_f32 v15, v196, v197, v15
    v_max3_f32 v15, v198, v199, v15
    v_mfma_f32_32x32x16_bf16 v[208:223], v[48:51], v[80:83], v[208:223]
    ds_read_b128 v[40:43], v18 offset:0
    v_max3_f32 v15, v200, v201, v15
    v_max3_f32 v15, v202, v203, v15
    v_mfma_f32_32x32x16_bf16 v[208:223], v[52:55], v[84:87], v[208:223]
    ds_read_b128 v[44:47], v19 offset:0
    v_max3_f32 v15, v204, v205, v15
    v_max3_f32 v15, v206, v207, v15
    v_mfma_f32_32x32x16_bf16 v[208:223], v[56:59], v[88:91], v[208:223]
    ds_read_b128 v[48:51], v20 offset:0
    v_mfma_f32_32x32x16_bf16 v[208:223], v[60:63], v[92:95], v[208:223]
    ds_read_b128 v[52:55], v21 offset:0
    s_waitcnt lgkmcnt(2)
    v_mfma_f32_32x32x16_bf16 v[224:239], v[32:35], v[64:67], 0
    ds_read_b128 v[56:59], v22 offset:0
    v_mfma_f32_32x32x16_bf16 v[224:239], v[36:39], v[68:71], v[224:239]
    ds_read_b128 v[60:63], v23 offset:0
    s_nop 5
    v_max3_f32 v15, v208, v209, v15
    v_max3_f32 v15, v210, v211, v15
    v_max3_f32 v15, v212, v213, v15
    v_mfma_f32_32x32x16_bf16 v[224:239], v[40:43], v[72:75], v[224:239]
    ds_read_b128 v[32:35], v16 offset:8192
    ds_read_b128 v[36:39], v17 offset:8192
    v_max3_f32 v15, v214, v215, v15
    v_max3_f32 v15, v216, v217, v15
    v_max3_f32 v15, v218, v219, v15
    v_mfma_f32_32x32x16_bf16 v[224:239], v[44:47], v[76:79], v[224:239]
    ds_read_b128 v[40:43], v18 offset:8192
    v_max3_f32 v15, v220, v221, v15
    v_max3_f32 v15, v222, v223, v15
    v_mov_b32 v24, v15
    s_nop 1
    v_permlane32_swap_b32 v24, v15
    v_max_f32 v15, v24, v15
    v_mov_b32 v9, v15
    v_sub_f32 v3, 0, v15
    v_and_b32 v24, s30, v3
    v_lshrrev_b32 v2, 16, v3
    v_sub_f32 v3, v3, v24
    v_and_b32 v24, s30, v3
    v_or_b32 v2, v2, v24
    v_sub_f32 v3, v3, v24
    v_lshrrev_b32 v3, 16, v3
    s_nop 1
    v_mfma_f32_32x32x16_bf16 v[192:207], v[4:7], v[2:5], v[192:207]
    s_waitcnt lgkmcnt(3)
    v_mfma_f32_32x32x16_bf16 v[224:239], v[48:51], v[80:83], v[224:239]
    ds_read_b128 v[44:47], v19 offset:8192
    v_mfma_f32_32x32x16_bf16 v[224:239], v[52:55], v[84:87], v[224:239]
    ds_read_b128 v[48:51], v20 offset:8192
    v_mfma_f32_32x32x16_bf16 v[224:239], v[56:59], v[88:91], v[224:239]
    ds_read_b128 v[52:55], v21 offset:8192
    s_nop 4
    v_exp_f32 v192, v192
    v_exp_f32 v193, v193
    v_exp_f32 v194, v194
    v_exp_f32 v195, v195
    v_add_f32 v10, v10, v192
    v_mfma_f32_32x32x16_bf16 v[224:239], v[60:63], v[92:95], v[224:239]
    ds_read_b128 v[56:59], v22 offset:8192
    v_add_f32 v11, v11, v193
    v_cvt_pk_bf16_f32 v96, v192, v193
    v_add_f32 v10, v10, v194
    v_add_f32 v11, v11, v195
    v_cvt_pk_bf16_f32 v97, v194, v195
    s_waitcnt lgkmcnt(3)
    v_mfma_f32_32x32x16_bf16 v[240:255], v[32:35], v[64:67], 0
    ds_read_b128 v[60:63], v23 offset:8192
    v_exp_f32 v196, v196
    v_exp_f32 v197, v197
    v_exp_f32 v198, v198
    v_exp_f32 v199, v199
    v_add_f32 v10, v10, v196
    v_mfma_f32_32x32x16_bf16 v[240:255], v[36:39], v[68:71], v[240:255]
    v_add_u32 v16, 65536, v1
    v_xor_b32 v17, 32, v16
    v_xor_b32 v18, 64, v16
    v_xor_b32 v19, 96, v16
    v_mfma_f32_32x32x16_bf16 v[208:223], v[4:7], v[2:5], v[208:223]
    v_add_f32 v11, v11, v197
    v_cvt_pk_bf16_f32 v98, v196, v197
    v_add_f32 v10, v10, v198
    v_add_f32 v11, v11, v199
    v_cvt_pk_bf16_f32 v99, v198, v199
    v_mfma_f32_32x32x16_bf16 v[240:255], v[40:43], v[72:75], v[240:255]
    v_xor_b32 v20, 128, v16
    v_xor_b32 v21, 160, v16
    v_xor_b32 v22, 192, v16
    v_xor_b32 v23, 224, v16
    v_exp_f32 v200, v200
    v_exp_f32 v201, v201
    v_exp_f32 v202, v202
    v_exp_f32 v203, v203
    v_add_f32 v10, v10, v200
    v_mfma_f32_32x32x16_bf16 v[240:255], v[44:47], v[76:79], v[240:255]
    s_waitcnt lgkmcnt(0)
    s_barrier
    ds_read_b128 v[32:35], v16 offset:0
    ds_read_b128 v[36:39], v17 offset:0
    v_add_f32 v11, v11, v201
    v_cvt_pk_bf16_f32 v100, v200, v201
    v_add_f32 v10, v10, v202
    v_add_f32 v11, v11, v203
    v_cvt_pk_bf16_f32 v101, v202, v203
    v_max3_f32 v15, v224, v225, v15
    v_max3_f32 v15, v226, v227, v15
    v_mfma_f32_32x32x16_bf16 v[240:255], v[48:51], v[80:83], v[240:255]
    ds_read_b128 v[40:43], v18 offset:0
    v_exp_f32 v204, v204
    v_exp_f32 v205, v205
    v_exp_f32 v206, v206
    v_exp_f32 v207, v207
    v_add_f32 v10, v10, v204
    v_max3_f32 v15, v228, v229, v15
    v_mfma_f32_32x32x16_bf16 v[240:255], v[52:55], v[84:87], v[240:255]
    ds_read_b128 v[44:47], v19 offset:0
    v_add_f32 v11, v11, v205
    v_cvt_pk_bf16_f32 v102, v204, v205
    v_add_f32 v10, v10, v206
    v_add_f32 v11, v11, v207
    v_cvt_pk_bf16_f32 v103, v206, v207
    v_max3_f32 v15, v230, v231, v15
    v_mfma_f32_32x32x16_bf16 v[240:255], v[56:59], v[88:91], v[240:255]
    ds_read_b128 v[48:51], v20 offset:0
    v_exp_f32 v208, v208
    v_exp_f32 v209, v209
    v_exp_f32 v210, v210
    v_exp_f32 v211, v211
    v_add_f32 v10, v10, v208
    v_max3_f32 v15, v232, v233, v15
    v_max3_f32 v15, v234, v235, v15
    v_mfma_f32_32x32x16_bf16 v[240:255], v[60:63], v[92:95], v[240:255]
    ds_read_b128 v[52:55], v21 offset:0
    v_add_f32 v11, v11, v209
    v_cvt_pk_bf16_f32 v104, v208, v209
    v_add_f32 v10, v10, v210
    v_add_f32 v11, v11, v211
    v_cvt_pk_bf16_f32 v105, v210, v211
    v_max3_f32 v15, v236, v237, v15
    s_waitcnt lgkmcnt(2)
    v_mfma_f32_32x32x16_bf16 v[192:207], v[32:35], v[64:67], 0
    ds_read_b128 v[56:59], v22 offset:0
    v_exp_f32 v212, v212
    v_exp_f32 v213, v213
    v_exp_f32 v214, v214
    v_exp_f32 v215, v215
    v_add_f32 v10, v10, v212
    v_max3_f32 v15, v238, v239, v15
    v_mfma_f32_32x32x16_bf16 v[192:207], v[36:39], v[68:71], v[192:207]
    ds_read_b128 v[60:63], v23 offset:0
    v_max3_f32 v15, v240, v241, v15
    v_max3_f32 v15, v242, v243, v15
    v_max3_f32 v15, v244, v245, v15
    v_add_f32 v11, v11, v213
    v_cvt_pk_bf16_f32 v106, v212, v213
    v_add_f32 v10, v10, v214
    v_add_f32 v11, v11, v215
    v_cvt_pk_bf16_f32 v107, v214, v215
    v_mfma_f32_32x32x16_bf16 v[192:207], v[40:43], v[72:75], v[192:207]
    ds_read_b128 v[32:35], v16 offset:8192
    ds_read_b128 v[36:39], v17 offset:8192
    v_max3_f32 v15, v246, v247, v15
    v_max3_f32 v15, v248, v249, v15
    v_max3_f32 v15, v250, v251, v15
    v_exp_f32 v216, v216
    v_exp_f32 v217, v217
    v_exp_f32 v218, v218
    v_exp_f32 v219, v219
    v_add_f32 v10, v10, v216
    v_mfma_f32_32x32x16_bf16 v[192:207], v[44:47], v[76:79], v[192:207]
    ds_read_b128 v[40:43], v18 offset:8192
    v_max3_f32 v15, v252, v253, v15
    v_max3_f32 v15, v254, v255, v15
    v_sub_f32 v24, v15, v9
    v_cmp_lt_f32 vcc, 0x41000000, v24
    s_nop 0
    s_cmp_lg_u64 vcc, 0
    s_cbranch_scc1 L_up1
L_upr1:
    v_mfma_f32_32x32x16_bf16 v[224:239], v[4:7], v[2:5], v[224:239]
    v_add_f32 v11, v11, v217
    v_cvt_pk_bf16_f32 v108, v216, v217
    v_add_f32 v10, v10, v218
    v_add_f32 v11, v11, v219
    v_cvt_pk_bf16_f32 v109, v218, v219
    s_waitcnt lgkmcnt(3)
    v_mfma_f32_32x32x16_bf16 v[192:207], v[48:51], v[80:83], v[192:207]
    ds_read_b128 v[44:47], v19 offset:8192
    v_exp_f32 v220, v220
    v_exp_f32 v221, v221
    v_exp_f32 v222, v222
    v_exp_f32 v223, v223
    v_add_f32 v10, v10, v220
    v_mfma_f32_32x32x16_bf16 v[192:207], v[52:55], v[84:87], v[192:207]
    ds_read_b128 v[48:51], v20 offset:8192
    v_add_f32 v11, v11, v221
    v_cvt_pk_bf16_f32 v110, v220, v221
    v_add_f32 v10, v10, v222
    v_add_f32 v11, v11, v223
    v_cvt_pk_bf16_f32 v111, v222, v223
    v_mfma_f32_32x32x16_bf16 v[192:207], v[56:59], v[88:91], v[192:207]
    ds_read_b128 v[52:55], v21 offset:8192
    v_exp_f32 v224, v224
    v_exp_f32 v225, v225
    v_exp_f32 v226, v226
    v_exp_f32 v227, v227
    v_add_f32 v10, v10, v224
    v_mfma_f32_32x32x16_bf16 v[192:207], v[60:63], v[92:95], v[192:207]
    ds_read_b128 v[56:59], v22 offset:8192
    v_add_f32 v11, v11, v225
    v_cvt_pk_bf16_f32 v112, v224, v225
    v_add_f32 v10, v10, v226
    v_add_f32 v11, v11, v227
    v_cvt_pk_bf16_f32 v113, v226, v227
    s_waitcnt lgkmcnt(3)
    v_mfma_f32_32x32x16_bf16 v[208:223], v[32:35], v[64:67], 0
    ds_read_b128 v[60:63], v23 offset:8192
    v_exp_f32 v228, v228
    v_exp_f32 v229, v229
    v_exp_f32 v230, v230
    v_exp_f32 v231, v231
    v_add_f32 v10, v10, v228
    v_mfma_f32_32x32x16_bf16 v[208:223], v[36:39], v[68:71], v[208:223]
    v_add_u32 v16, 98304, v1
    v_xor_b32 v17, 32, v16
    v_xor_b32 v18, 64, v16
    v_xor_b32 v19, 96, v16
    v_mfma_f32_32x32x16_bf16 v[240:255], v[4:7], v[2:5], v[240:255]
    v_add_f32 v11, v11, v229
    v_cvt_pk_bf16_f32 v114, v228, v229
    v_add_f32 v10, v10, v230
    v_add_f32 v11, v11, v231
    v_cvt_pk_bf16_f32 v115, v230, v231
    v_mfma_f32_32x32x16_bf16 v[208:223], v[40:43], v[72:75], v[208:223]
    v_xor_b32 v20, 128, v16
    v_xor_b32 v21, 160, v16
    v_xor_b32 v22, 192, v16
    v_xor_b32 v23, 224, v16
    v_exp_f32 v232, v232
    v_exp_f32 v233, v233
    v_exp_f32 v234, v234
    v_exp_f32 v235, v235
    v_add_f32 v10, v10, v232
    v_mfma_f32_32x32x16_bf16 v[208:223], v[44:47], v[76:79], v[208:223]
    s_waitcnt lgkmcnt(0)
    s_barrier
    ds_read_b128 v[32:35], v16 offset:0
    ds_read_b128 v[36:39], v17 offset:0
    v_add_f32 v11, v11, v233
    v_cvt_pk_bf16_f32 v116, v232, v233
    v_add_f32 v10, v10, v234
    v_add_f32 v11, v11, v235
    v_cvt_pk_bf16_f32 v117, v234, v235
    v_max3_f32 v15, v192, v193, v15
    v_max3_f32 v15, v194, v195, v15
    v_mfma_f32_32x32x16_bf16 v[208:223], v[48:51], v[80:83], v[208:223]
    ds_read_b128 v[40:43], v18 offset:0
    v_exp_f32 v236, v236
    v_exp_f32 v237, v237
    v_exp_f32 v238, v238
    v_exp_f32 v239, v239
    v_add_f32 v10, v10, v236
    v_max3_f32 v15, v196, v197, v15
    v_mfma_f32_32x32x16_bf16 v[208:223], v[52:55], v[84:87], v[208:223]
    ds_read_b128 v[44:47], v19 offset:0
    v_add_f32 v11, v11, v237
    v_cvt_pk_bf16_f32 v118, v236, v237
    v_add_f32 v10, v10, v238
    v_add_f32 v11, v11, v239
    v_cvt_pk_bf16_f32 v119, v238, v239
    v_max3_f32 v15, v198, v199, v15
    v_mfma_f32_32x32x16_bf16 v[208:223], v[56:59], v[88:91], v[208:223]
    ds_read_b128 v[48:51], v20 offset:0
    v_exp_f32 v240, v240
    v_exp_f32 v241, v241
    v_exp_f32 v242, v242
    v_exp_f32 v243, v243
    v_add_f32 v10, v10, v240
    v_max3_f32 v15, v200, v201, v15
    v_max3_f32 v15, v202, v203, v15
    v_mfma_f32_32x32x16_bf16 v[208:223], v[60:63], v[92:95], v[208:223]
    ds_read_b128 v[52:55], v21 offset:0
    v_add_f32 v11, v11, v241
    v_cvt_pk_bf16_f32 v120, v240, v241
    v_add_f32 v10, v10, v242
    v_add_f32 v11, v11, v243
    v_cvt_pk_bf16_f32 v121, v242, v243
    v_max3_f32 v15, v204, v205, v15
    s_waitcnt lgkmcnt(2)
    v_mfma_f32_32x32x16_bf16 v[224:239], v[32:35], v[64:67], 0
    ds_read_b128 v[56:59], v22 offset:0
    v_exp_f32 v244, v244
    v_exp_f32 v245, v245
    v_exp_f32 v246, v246
    v_exp_f32 v247, v247
    v_add_f32 v10, v10, v244
    v_max3_f32 v15, v206, v207, v15
    v_mfma_f32_32x32x16_bf16 v[224:239], v[36:39], v[68:71], v[224:239]
    ds_read_b128 v[60:63], v23 offset:0
    v_max3_f32 v15, v208, v209, v15
    v_max3_f32 v15, v210, v211, v15
    v_max3_f32 v15, v212, v213, v15
    v_add_f32 v11, v11, v245
    v_cvt_pk_bf16_f32 v122, v244, v245
    v_add_f32 v10, v10, v246
    v_add_f32 v11, v11, v247
    v_cvt_pk_bf16_f32 v123, v246, v247
    v_mfma_f32_32x32x16_bf16 v[224:239], v[40:43], v[72:75], v[224:239]
    ds_read_b128 v[32:35], v16 offset:8192
    ds_read_b128 v[36:39], v17 offset:8192
    v_max3_f32 v15, v214, v215, v15
    v_max3_f32 v15, v216, v217, v15
    v_max3_f32 v15, v218, v219, v15
    v_exp_f32 v248, v248
    v_exp_f32 v249, v249
    v_exp_f32 v250, v250
    v_exp_f32 v251, v251
    v_add_f32 v10, v10, v248
    v_mfma_f32_32x32x16_bf16 v[224:239], v[44:47], v[76:79], v[224:239]
    ds_read_b128 v[40:43], v18 offset:8192
    v_max3_f32 v15, v220, v221, v15
    v_max3_f32 v15, v222, v223, v15
    v_sub_f32 v24, v15, v9
    v_cmp_lt_f32 vcc, 0x41000000, v24
    s_nop 0
    s_cmp_lg_u64 vcc, 0
    s_cbranch_scc1 L_up2
L_upr2:
    v_mfma_f32_32x32x16_bf16 v[192:207], v[4:7], v[2:5], v[192:207]
    v_add_f32 v11, v11, v249
    v_cvt_pk_bf16_f32 v124, v248, v249
    v_add_f32 v10, v10, v250
    v_add_f32 v11, v11, v251
    v_cvt_pk_bf16_f32 v125, v250, v251
    s_waitcnt lgkmcnt(3)
    v_mfma_f32_32x32x16_bf16 v[224:239], v[48:51], v[80:83], v[224:239]
    ds_read_b128 v[44:47], v19 offset:8192
    v_exp_f32 v252, v252
    v_exp_f32 v253, v253
    v_exp_f32 v254, v254
    v_exp_f32 v255, v255
    v_add_f32 v10, v10, v252
    v_mfma_f32_32x32x16_bf16 v[224:239], v[52:55], v[84:87], v[224:239]
    ds_read_b128 v[48:51], v20 offset:8192
    v_add_f32 v11, v11, v253
    v_cvt_pk_bf16_f32 v126, v252, v253
    v_add_f32 v10, v10, v254
    v_add_f32 v11, v11, v255
    v_cvt_pk_bf16_f32 v127, v254, v255
    v_mfma_f32_32x32x16_bf16 v[224:239], v[56:59], v[88:91], v[224:239]
    ds_read_b128 v[52:55], v21 offset:8192
    v_exp_f32 v192, v192
    v_exp_f32 v193, v193
    v_exp_f32 v194, v194
    v_exp_f32 v195, v195
    v_add_f32 v10, v10, v192
    v_mfma_f32_32x32x16_bf16 v[224:239], v[60:63], v[92:95], v[224:239]
    ds_read_b128 v[56:59], v22 offset:8192
    v_add_f32 v11, v11, v193
    v_cvt_pk_bf16_f32 v128, v192, v193
    v_add_f32 v10, v10, v194
    v_add_f32 v11, v11, v195
    v_cvt_pk_bf16_f32 v129, v194, v195
    s_waitcnt lgkmcnt(3)
    v_mfma_f32_32x32x16_bf16 v[240:255], v[32:35], v[64:67], 0
    ds_read_b128 v[60:63], v23 offset:8192
    v_exp_f32 v196, v196
    v_exp_f32 v197, v197
    v_exp_f32 v198, v198
    v_exp_f32 v199, v199
    v_add_f32 v10, v10, v196
    v_mfma_f32_32x32x16_bf16 v[240:255], v[36:39], v[68:71], v[240:255]
    v_add_u32 v16, 131072, v1
    v_xor_b32 v17, 32, v16
    v_xor_b32 v18, 64, v16
    v_xor_b32 v19, 96, v16
    v_mfma_f32_32x32x16_bf16 v[208:223], v[4:7], v[2:5], v[208:223]
    v_add_f32 v11, v11, v197
    v_cvt_pk_bf16_f32 v130, v196, v197
    v_add_f32 v10, v10, v198
    v_add_f32 v11, v11, v199
    v_cvt_pk_bf16_f32 v131, v198, v199
    v_mfma_f32_32x32x16_bf16 v[240:255], v[40:43], v[72:75], v[240:255]
    v_xor_b32 v20, 128, v16
    v_xor_b32 v21, 160, v16
    v_xor_b32 v22, 192, v16
    v_xor_b32 v23, 224, v16
    v_exp_f32 v200, v200
    v_exp_f32 v201, v201
    v_exp_f32 v202, v202
    v_exp_f32 v203, v203
    v_add_f32 v10, v10, v200
    v_mfma_f32_32x32x16_bf16 v[240:255], v[44:47], v[76:79], v[240:255]
    s_waitcnt lgkmcnt(0)
    s_barrier
    ds_read_b128 v[32:35], v16 offset:0
    ds_read_b128 v[36:39], v17 offset:0
    v_add_f32 v11, v11, v201
    v_cvt_pk_bf16_f32 v132, v200, v201
    v_add_f32 v10, v10, v202
    v_add_f32 v11, v11, v203
    v_cvt_pk_bf16_f32 v133, v202, v203
    v_max3_f32 v15, v224, v225, v15
    v_max3_f32 v15, v226, v227, v15
    v_mfma_f32_32x32x16_bf16 v[240:255], v[48:51], v[80:83], v[240:255]
    ds_read_b128 v[40:43], v18 offset:0
    v_exp_f32 v204, v204
    v_exp_f32 v205, v205
    v_exp_f32 v206, v206
    v_exp_f32 v207, v207
    v_add_f32 v10, v10, v204
    v_max3_f32 v15, v228, v229, v15
    v_mfma_f32_32x32x16_bf16 v[240:255], v[52:55], v[84:87], v[240:255]
    ds_read_b128 v[44:47], v19 offset:0
    v_add_f32 v11, v11, v205
    v_cvt_pk_bf16_f32 v134, v204, v205
    v_add_f32 v10, v10, v206
    v_add_f32 v11, v11, v207
    v_cvt_pk_bf16_f32 v135, v206, v207
    v_max3_f32 v15, v230, v231, v15
    v_mfma_f32_32x32x16_bf16 v[240:255], v[56:59], v[88:91], v[240:255]
    ds_read_b128 v[48:51], v20 offset:0
    v_exp_f32 v208, v208
    v_exp_f32 v209, v209
    v_exp_f32 v210, v210
    v_exp_f32 v211, v211
    v_add_f32 v10, v10, v208
    v_max3_f32 v15, v232, v233, v15
    v_max3_f32 v15, v234, v235, v15
    v_mfma_f32_32x32x16_bf16 v[240:255], v[60:63], v[92:95], v[240:255]
    ds_read_b128 v[52:55], v21 offset:0
    v_add_f32 v11, v11, v209
    v_cvt_pk_bf16_f32 v136, v208, v209
    v_add_f32 v10, v10, v210
    v_add_f32 v11, v11, v211
    v_cvt_pk_bf16_f32 v137, v210, v211
    v_max3_f32 v15, v236, v237, v15
    s_waitcnt lgkmcnt(2)
    v_mfma_f32_32x32x16_bf16 v[192:207], v[32:35], v[64:67], 0
    ds_read_b128 v[56:59], v22 offset:0
    v_exp_f32 v212, v212
    v_exp_f32 v213, v213
    v_exp_f32 v214, v214
    v_exp_f32 v215, v215
    v_add_f32 v10, v10, v212
    v_max3_f32 v15, v238, v239, v15
    v_mfma_f32_32x32x16_bf16 v[192:207], v[36:39], v[68:71], v[192:207]
    ds_read_b128 v[60:63], v23 offset:0
    v_max3_f32 v15, v240, v241, v15
    v_max3_f32 v15, v242, v243, v15
    v_max3_f32 v15, v244, v245, v15
    v_add_f32 v11, v11, v213
    v_cvt_pk_bf16_f32 v138, v212, v213
    v_add_f32 v10, v10, v214
    v_add_f32 v11, v11, v215
    v_cvt_pk_bf16_f32 v139, v214, v215
    v_mfma_f32_32x32x16_bf16 v[192:207], v[40:43], v[72:75], v[192:207]
    ds_read_b128 v[32:35], v16 offset:8192
    ds_read_b128 v[36:39], v17 offset:8192
    v_max3_f32 v15, v246, v247, v15
    v_max3_f32 v15, v248, v249, v15
    v_max3_f32 v15, v250, v251, v15
    v_exp_f32 v216, v216
    v_exp_f32 v217, v217
    v_exp_f32 v218, v218
    v_exp_f32 v219, v219
    v_add_f32 v10, v10, v216
    v_mfma_f32_32x32x16_bf16 v[192:207], v[44:47], v[76:79], v[192:207]
    ds_read_b128 v[40:43], v18 offset:8192
    v_max3_f32 v15, v252, v253, v15
    v_max3_f32 v15, v254, v255, v15
    v_sub_f32 v24, v15, v9
    v_cmp_lt_f32 vcc, 0x41000000, v24
    s_nop 0
    s_cmp_lg_u64 vcc, 0
    s_cbranch_scc1 L_up3
L_upr3:
    v_mfma_f32_32x32x16_bf16 v[224:239], v[4:7], v[2:5], v[224:239]
    v_add_f32 v11, v11, v217
    v_cvt_pk_bf16_f32 v140, v216, v217
    v_add_f32 v10, v10, v218
    v_add_f32 v11, v11, v219
    v_cvt_pk_bf16_f32 v141, v218, v219
    s_waitcnt lgkmcnt(3)
    v_mfma_f32_32x32x16_bf16 v[192:207], v[48:51], v[80:83], v[192:207]
    ds_read_b128 v[44:47], v19 offset:8192
    v_exp_f32 v220, v220
    v_exp_f32 v221, v221
    v_exp_f32 v222, v222
    v_exp_f32 v223, v223
    v_add_f32 v10, v10, v220
    v_mfma_f32_32x32x16_bf16 v[192:207], v[52:55], v[84:87], v[192:207]
    ds_read_b128 v[48:51], v20 offset:8192
    v_add_f32 v11, v11, v221
    v_cvt_pk_bf16_f32 v142, v220, v221
    v_add_f32 v10, v10, v222
    v_add_f32 v11, v11, v223
    v_cvt_pk_bf16_f32 v143, v222, v223
    v_mfma_f32_32x32x16_bf16 v[192:207], v[56:59], v[88:91], v[192:207]
    ds_read_b128 v[52:55], v21 offset:8192
    v_exp_f32 v224, v224
    v_exp_f32 v225, v225
    v_exp_f32 v226, v226
    v_exp_f32 v227, v227
    v_add_f32 v10, v10, v224
    v_mfma_f32_32x32x16_bf16 v[192:207], v[60:63], v[92:95], v[192:207]
    ds_read_b128 v[56:59], v22 offset:8192
    v_add_f32 v11, v11, v225
    v_cvt_pk_bf16_f32 v144, v224, v225
    v_add_f32 v10, v10, v226
    v_add_f32 v11, v11, v227
    v_cvt_pk_bf16_f32 v145, v226, v227
    s_waitcnt lgkmcnt(3)
    v_mfma_f32_32x32x16_bf16 v[208:223], v[32:35], v[64:67], 0
    ds_read_b128 v[60:63], v23 offset:8192
    v_exp_f32 v228, v228
    v_exp_f32 v229, v229
    v_exp_f32 v230, v230
    v_exp_f32 v231, v231
    v_add_f32 v10, v10, v228
    v_mfma_f32_32x32x16_bf16 v[208:223], v[36:39], v[68:71], v[208:223]
    v_mov_b32 v16, v1
    v_xor_b32 v17, 32, v16
    v_xor_b32 v18, 64, v16
    v_xor_b32 v19, 96, v16
    v_mfma_f32_32x32x16_bf16 v[240:255], v[4:7], v[2:5], v[240:255]
    v_add_f32 v11, v11, v229
    v_cvt_pk_bf16_f32 v146, v228, v229
    v_add_f32 v10, v10, v230
    v_add_f32 v11, v11, v231
    v_cvt_pk_bf16_f32 v147, v230, v231
    v_mfma_f32_32x32x16_bf16 v[208:223], v[40:43], v[72:75], v[208:223]
    v_xor_b32 v20, 128, v16
    v_xor_b32 v21, 160, v16
    v_xor_b32 v22, 192, v16
    v_xor_b32 v23, 224, v16
    v_exp_f32 v232, v232
    v_exp_f32 v233, v233
    v_exp_f32 v234, v234
    v_exp_f32 v235, v235
    v_add_f32 v10, v10, v232
    v_mfma_f32_32x32x16_bf16 v[208:223], v[44:47], v[76:79], v[208:223]
    s_waitcnt lgkmcnt(0)
    s_barrier
    ds_read_b128 v[32:35], v16 offset:0
    ds_read_b128 v[36:39], v17 offset:0
    v_add_f32 v11, v11, v233
    v_cvt_pk_bf16_f32 v148, v232, v233
    v_add_f32 v10, v10, v234
    v_add_f32 v11, v11, v235
    v_cvt_pk_bf16_f32 v149, v234, v235
    v_max3_f32 v15, v192, v193, v15
    v_max3_f32 v15, v194, v195, v15
    v_mfma_f32_32x32x16_bf16 v[208:223], v[48:51], v[80:83], v[208:223]
    ds_read_b128 v[40:43], v18 offset:0
    v_exp_f32 v236, v236
    v_exp_f32 v237, v237
    v_exp_f32 v238, v238
    v_exp_f32 v239, v239
    v_add_f32 v10, v10, v236
    v_max3_f32 v15, v196, v197, v15
    v_mfma_f32_32x32x16_bf16 v[208:223], v[52:55], v[84:87], v[208:223]
    ds_read_b128 v[44:47], v19 offset:0
    v_add_f32 v11, v11, v237
    v_cvt_pk_bf16_f32 v150, v236, v237
    v_add_f32 v10, v10, v238
    v_add_f32 v11, v11, v239
    v_cvt_pk_bf16_f32 v151, v238, v239
    v_max3_f32 v15, v198, v199, v15
    v_mfma_f32_32x32x16_bf16 v[208:223], v[56:59], v[88:91], v[208:223]
    ds_read_b128 v[48:51], v20 offset:0
    v_exp_f32 v240, v240
    v_exp_f32 v241, v241
    v_exp_f32 v242, v242
    v_exp_f32 v243, v243
    v_add_f32 v10, v10, v240
    v_max3_f32 v15, v200, v201, v15
    v_max3_f32 v15, v202, v203, v15
    v_mfma_f32_32x32x16_bf16 v[208:223], v[60:63], v[92:95], v[208:223]
    ds_read_b128 v[52:55], v21 offset:0
    v_add_f32 v11, v11, v241
    v_cvt_pk_bf16_f32 v152, v240, v241
    v_add_f32 v10, v10, v242
    v_add_f32 v11, v11, v243
    v_cvt_pk_bf16_f32 v153, v242, v243
    v_max3_f32 v15, v204, v205, v15
    s_waitcnt lgkmcnt(2)
    v_mfma_f32_32x32x16_bf16 v[224:239], v[32:35], v[64:67], 0
    ds_read_b128 v[56:59], v22 offset:0
    v_exp_f32 v244, v244
    v_exp_f32 v245, v245
    v_exp_f32 v246, v246
    v_exp_f32 v247, v247
    v_add_f32 v10, v10, v244
    v_max3_f32 v15, v206, v207, v15
    v_mfma_f32_32x32x16_bf16 v[224:239], v[36:39], v[68:71], v[224:239]
    ds_read_b128 v[60:63], v23 offset:0
    v_max3_f32 v15, v208, v209, v15
    v_max3_f32 v15, v210, v211, v15
    v_max3_f32 v15, v212, v213, v15
    v_add_f32 v11, v11, v245
    v_cvt_pk_bf16_f32 v154, v244, v245
    v_add_f32 v10, v10, v246
    v_add_f32 v11, v11, v247
    v_cvt_pk_bf16_f32 v155, v246, v247
    v_mfma_f32_32x32x16_bf16 v[224:239], v[40:43], v[72:75], v[224:239]
    ds_read_b128 v[32:35], v16 offset:8192
    ds_read_b128 v[36:39], v17 offset:8192
    v_max3_f32 v15, v214, v215, v15
    v_max3_f32 v15, v216, v217, v15
    v_max3_f32 v15, v218, v219, v15
    v_exp_f32 v248, v248
    v_exp_f32 v249, v249
    v_exp_f32 v250, v250
    v_exp_f32 v251, v251
    v_add_f32 v10, v10, v248
    v_mfma_f32_32x32x16_bf16 v[224:239], v[44:47], v[76:79], v[224:239]
    ds_read_b128 v[40:43], v18 offset:8192
    v_max3_f32 v15, v220, v221, v15
    v_max3_f32 v15, v222, v223, v15
    v_sub_f32 v24, v15, v9
    v_cmp_lt_f32 vcc, 0x41000000, v24
    s_nop 0
    s_cmp_lg_u64 vcc, 0
    s_cbranch_scc1 L_up4
L_upr4:
    v_mfma_f32_32x32x16_bf16 v[192:207], v[4:7], v[2:5], v[192:207]
    v_add_f32 v11, v11, v249
    v_cvt_pk_bf16_f32 v156, v248, v249
    v_add_f32 v10, v10, v250
    v_add_f32 v11, v11, v251
    v_cvt_pk_bf16_f32 v157, v250, v251
    s_waitcnt lgkmcnt(3)
    v_mfma_f32_32x32x16_bf16 v[224:239], v[48:51], v[80:83], v[224:239]
    ds_read_b128 v[44:47], v19 offset:8192
    v_exp_f32 v252, v252
    v_exp_f32 v253, v253
    v_exp_f32 v254, v254
    v_exp_f32 v255, v255
    v_add_f32 v10, v10, v252
    v_mfma_f32_32x32x16_bf16 v[224:239], v[52:55], v[84:87], v[224:239]
    ds_read_b128 v[48:51], v20 offset:8192
    v_add_f32 v11, v11, v253
    v_cvt_pk_bf16_f32 v158, v252, v253
    v_add_f32 v10, v10, v254
    v_add_f32 v11, v11, v255
    v_cvt_pk_bf16_f32 v159, v254, v255
    v_mfma_f32_32x32x16_bf16 v[224:239], v[56:59], v[88:91], v[224:239]
    ds_read_b128 v[52:55], v21 offset:8192
    v_exp_f32 v192, v192
    v_exp_f32 v193, v193
    v_exp_f32 v194, v194
    v_exp_f32 v195, v195
    v_add_f32 v10, v10, v192
    v_mfma_f32_32x32x16_bf16 v[224:239], v[60:63], v[92:95], v[224:239]
    ds_read_b128 v[56:59], v22 offset:8192
    v_add_f32 v11, v11, v193
    v_cvt_pk_bf16_f32 v160, v192, v193
    v_add_f32 v10, v10, v194
    v_add_f32 v11, v11, v195
    v_cvt_pk_bf16_f32 v161, v194, v195
    s_waitcnt lgkmcnt(3)
    v_mfma_f32_32x32x16_bf16 v[240:255], v[32:35], v[64:67], 0
    ds_read_b128 v[60:63], v23 offset:8192
    v_exp_f32 v196, v196
    v_exp_f32 v197, v197
    v_exp_f32 v198, v198
    v_exp_f32 v199, v199
    v_add_f32 v10, v10, v196
    v_mfma_f32_32x32x16_bf16 v[240:255], v[36:39], v[68:71], v[240:255]
    v_add_u32 v16, 32768, v1
    v_xor_b32 v17, 32, v16
    v_xor_b32 v18, 64, v16
    v_xor_b32 v19, 96, v16
    v_mfma_f32_32x32x16_bf16 v[208:223], v[4:7], v[2:5], v[208:223]
    v_add_f32 v11, v11, v197
    v_cvt_pk_bf16_f32 v162, v196, v197
    v_add_f32 v10, v10, v198
    v_add_f32 v11, v11, v199
    v_cvt_pk_bf16_f32 v163, v198, v199
    v_mfma_f32_32x32x16_bf16 v[240:255], v[40:43], v[72:75], v[240:255]
    v_xor_b32 v20, 128, v16
    v_xor_b32 v21, 160, v16
    v_xor_b32 v22, 192, v16
    v_xor_b32 v23, 224, v16
    v_exp_f32 v200, v200
    v_exp_f32 v201, v201
    v_exp_f32 v202, v202
    v_exp_f32 v203, v203
    v_add_f32 v10, v10, v200
    v_mfma_f32_32x32x16_bf16 v[240:255], v[44:47], v[76:79], v[240:255]
    s_waitcnt lgkmcnt(0)
    s_barrier
    ds_read_b128 v[32:35], v16 offset:0
    ds_read_b128 v[36:39], v17 offset:0
    v_add_f32 v11, v11, v201
    v_cvt_pk_bf16_f32 v164, v200, v201
    v_add_f32 v10, v10, v202
    v_add_f32 v11, v11, v203
    v_cvt_pk_bf16_f32 v165, v202, v203
    v_max3_f32 v15, v224, v225, v15
    v_max3_f32 v15, v226, v227, v15
    v_mfma_f32_32x32x16_bf16 v[240:255], v[48:51], v[80:83], v[240:255]
    ds_read_b128 v[40:43], v18 offset:0
    v_exp_f32 v204, v204
    v_exp_f32 v205, v205
    v_exp_f32 v206, v206
    v_exp_f32 v207, v207
    v_add_f32 v10, v10, v204
    v_max3_f32 v15, v228, v229, v15
    v_mfma_f32_32x32x16_bf16 v[240:255], v[52:55], v[84:87], v[240:255]
    ds_read_b128 v[44:47], v19 offset:0
    v_add_f32 v11, v11, v205
    v_cvt_pk_bf16_f32 v166, v204, v205
    v_add_f32 v10, v10, v206
    v_add_f32 v11, v11, v207
    v_cvt_pk_bf16_f32 v167, v206, v207
    v_max3_f32 v15, v230, v231, v15
    v_mfma_f32_32x32x16_bf16 v[240:255], v[56:59], v[88:91], v[240:255]
    ds_read_b128 v[48:51], v20 offset:0
    v_exp_f32 v208, v208
    v_exp_f32 v209, v209
    v_exp_f32 v210, v210
    v_exp_f32 v211, v211
    v_add_f32 v10, v10, v208
    v_max3_f32 v15, v232, v233, v15
    v_max3_f32 v15, v234, v235, v15
    v_mfma_f32_32x32x16_bf16 v[240:255], v[60:63], v[92:95], v[240:255]
    ds_read_b128 v[52:55], v21 offset:0
    v_add_f32 v11, v11, v209
    v_cvt_pk_bf16_f32 v168, v208, v209
    v_add_f32 v10, v10, v210
    v_add_f32 v11, v11, v211
    v_cvt_pk_bf16_f32 v169, v210, v211
    v_max3_f32 v15, v236, v237, v15
    s_waitcnt lgkmcnt(2)
    v_mfma_f32_32x32x16_bf16 v[192:207], v[32:35], v[64:67], 0
    ds_read_b128 v[56:59], v22 offset:0
    v_exp_f32 v212, v212
    v_exp_f32 v213, v213
    v_exp_f32 v214, v214
    v_exp_f32 v215, v215
    v_add_f32 v10, v10, v212
    v_max3_f32 v15, v238, v239, v15
    v_mfma_f32_32x32x16_bf16 v[192:207], v[36:39], v[68:71], v[192:207]
    ds_read_b128 v[60:63], v23 offset:0
    v_max3_f32 v15, v240, v241, v15
    v_max3_f32 v15, v242, v243, v15
    v_max3_f32 v15, v244, v245, v15
    v_add_f32 v11, v11, v213
    v_cvt_pk_bf16_f32 v170, v212, v213
    v_add_f32 v10, v10, v214
    v_add_f32 v11, v11, v215
    v_cvt_pk_bf16_f32 v171, v214, v215
    v_mfma_f32_32x32x16_bf16 v[192:207], v[40:43], v[72:75], v[192:207]
    ds_read_b128 v[32:35], v16 offset:8192
    ds_read_b128 v[36:39], v17 offset:8192
    v_max3_f32 v15, v246, v247, v15
    v_max3_f32 v15, v248, v249, v15
    v_max3_f32 v15, v250, v251, v15
    v_exp_f32 v216, v216
    v_exp_f32 v217, v217
    v_exp_f32 v218, v218
    v_exp_f32 v219, v219
    v_add_f32 v10, v10, v216
    v_mfma_f32_32x32x16_bf16 v[192:207], v[44:47], v[76:79], v[192:207]
    ds_read_b128 v[40:43], v18 offset:8192
    v_max3_f32 v15, v252, v253, v15
    v_max3_f32 v15, v254, v255, v15
    v_sub_f32 v24, v15, v9
    v_cmp_lt_f32 vcc, 0x41000000, v24
    s_nop 0
    s_cmp_lg_u64 vcc, 0
    s_cbranch_scc1 L_up5
L_upr5:
    v_mfma_f32_32x32x16_bf16 v[224:239], v[4:7], v[2:5], v[224:239]
    v_add_f32 v11, v11, v217
    v_cvt_pk_bf16_f32 v172, v216, v217
    v_add_f32 v10, v10, v218
    v_add_f32 v11, v11, v219
    v_cvt_pk_bf16_f32 v173, v218, v219
    s_waitcnt lgkmcnt(3)
    v_mfma_f32_32x32x16_bf16 v[192:207], v[48:51], v[80:83], v[192:207]
    ds_read_b128 v[44:47], v19 offset:8192
    v_exp_f32 v220, v220
    v_exp_f32 v221, v221
    v_exp_f32 v222, v222
    v_exp_f32 v223, v223
    v_add_f32 v10, v10, v220
    v_mfma_f32_32x32x16_bf16 v[192:207], v[52:55], v[84:87], v[192:207]
    ds_read_b128 v[48:51], v20 offset:8192
    v_add_f32 v11, v11, v221
    v_cvt_pk_bf16_f32 v174, v220, v221
    v_add_f32 v10, v10, v222
    v_add_f32 v11, v11, v223
    v_cvt_pk_bf16_f32 v175, v222, v223
    v_mfma_f32_32x32x16_bf16 v[192:207], v[56:59], v[88:91], v[192:207]
    ds_read_b128 v[52:55], v21 offset:8192
    v_exp_f32 v224, v224
    v_exp_f32 v225, v225
    v_exp_f32 v226, v226
    v_exp_f32 v227, v227
    v_add_f32 v10, v10, v224
    v_mfma_f32_32x32x16_bf16 v[192:207], v[60:63], v[92:95], v[192:207]
    ds_read_b128 v[56:59], v22 offset:8192
    v_add_f32 v11, v11, v225
    v_cvt_pk_bf16_f32 v176, v224, v225
    v_add_f32 v10, v10, v226
    v_add_f32 v11, v11, v227
    v_cvt_pk_bf16_f32 v177, v226, v227
    s_waitcnt lgkmcnt(3)
    v_mfma_f32_32x32x16_bf16 v[208:223], v[32:35], v[64:67], 0
    ds_read_b128 v[60:63], v23 offset:8192
    v_exp_f32 v228, v228
    v_exp_f32 v229, v229
    v_exp_f32 v230, v230
    v_exp_f32 v231, v231
    v_add_f32 v10, v10, v228
    v_mfma_f32_32x32x16_bf16 v[208:223], v[36:39], v[68:71], v[208:223]
    v_add_u32 v16, 65536, v1
    v_xor_b32 v17, 32, v16
    v_xor_b32 v18, 64, v16
    v_xor_b32 v19, 96, v16
    v_mfma_f32_32x32x16_bf16 v[240:255], v[4:7], v[2:5], v[240:255]
    v_add_f32 v11, v11, v229
    v_cvt_pk_bf16_f32 v178, v228, v229
    v_add_f32 v10, v10, v230
    v_add_f32 v11, v11, v231
    v_cvt_pk_bf16_f32 v179, v230, v231
    v_mfma_f32_32x32x16_bf16 v[208:223], v[40:43], v[72:75], v[208:223]
    v_xor_b32 v20, 128, v16
    v_xor_b32 v21, 160, v16
    v_xor_b32 v22, 192, v16
    v_xor_b32 v23, 224, v16
    v_exp_f32 v232, v232
    v_exp_f32 v233, v233
    v_exp_f32 v234, v234
    v_exp_f32 v235, v235
    v_add_f32 v10, v10, v232
    v_mfma_f32_32x32x16_bf16 v[208:223], v[44:47], v[76:79], v[208:223]
    s_waitcnt lgkmcnt(0)
    s_barrier
    ds_read_b128 v[32:35], v16 offset:0
    ds_read_b128 v[36:39], v17 offset:0
    v_add_f32 v11, v11, v233
    v_cvt_pk_bf16_f32 v180, v232, v233
    v_add_f32 v10, v10, v234
    v_add_f32 v11, v11, v235
    v_cvt_pk_bf16_f32 v181, v234, v235
    v_max3_f32 v15, v192, v193, v15
    v_max3_f32 v15, v194, v195, v15
    v_mfma_f32_32x32x16_bf16 v[208:223], v[48:51], v[80:83], v[208:223]
    ds_read_b128 v[40:43], v18 offset:0
    v_exp_f32 v236, v236
    v_exp_f32 v237, v237
    v_exp_f32 v238, v238
    v_exp_f32 v239, v239
    v_add_f32 v10, v10, v236
    v_max3_f32 v15, v196, v197, v15
    v_mfma_f32_32x32x16_bf16 v[208:223], v[52:55], v[84:87], v[208:223]
    ds_read_b128 v[44:47], v19 offset:0
    v_add_f32 v11, v11, v237
    v_cvt_pk_bf16_f32 v182, v236, v237
    v_add_f32 v10, v10, v238
    v_add_f32 v11, v11, v239
    v_cvt_pk_bf16_f32 v183, v238, v239
    v_max3_f32 v15, v198, v199, v15
    v_mfma_f32_32x32x16_bf16 v[208:223], v[56:59], v[88:91], v[208:223]
    ds_read_b128 v[48:51], v20 offset:0
    v_exp_f32 v240, v240
    v_exp_f32 v241, v241
    v_exp_f32 v242, v242
    v_exp_f32 v243, v243
    v_add_f32 v10, v10, v240
    v_max3_f32 v15, v200, v201, v15
    v_max3_f32 v15, v202, v203, v15
    v_mfma_f32_32x32x16_bf16 v[208:223], v[60:63], v[92:95], v[208:223]
    ds_read_b128 v[52:55], v21 offset:0
    v_add_f32 v11, v11, v241
    v_cvt_pk_bf16_f32 v184, v240, v241
    v_add_f32 v10, v10, v242
    v_add_f32 v11, v11, v243
    v_cvt_pk_bf16_f32 v185, v242, v243
    v_max3_f32 v15, v204, v205, v15
    s_waitcnt lgkmcnt(2)
    v_mfma_f32_32x32x16_bf16 v[224:239], v[32:35], v[64:67], 0
    ds_read_b128 v[56:59], v22 offset:0
    v_exp_f32 v244, v244
    v_exp_f32 v245, v245
    v_exp_f32 v246, v246
    v_exp_f32 v247, v247
    v_add_f32 v10, v10, v244
    v_max3_f32 v15, v206, v207, v15
    v_mfma_f32_32x32x16_bf16 v[224:239], v[36:39], v[68:71], v[224:239]
    ds_read_b128 v[60:63], v23 offset:0
    v_max3_f32 v15, v208, v209, v15
    v_max3_f32 v15, v210, v211, v15
    v_max3_f32 v15, v212, v213, v15
    v_add_f32 v11, v11, v245
    v_cvt_pk_bf16_f32 v186, v244, v245
    v_add_f32 v10, v10, v246
    v_add_f32 v11, v11, v247
    v_cvt_pk_bf16_f32 v187, v246, v247
    v_mfma_f32_32x32x16_bf16 v[224:239], v[40:43], v[72:75], v[224:239]
    ds_read_b128 v[32:35], v16 offset:8192
    ds_read_b128 v[36:39], v17 offset:8192
    v_max3_f32 v15, v214, v215, v15
    v_max3_f32 v15, v216, v217, v15
    v_max3_f32 v15, v218, v219, v15
    v_exp_f32 v248, v248
    v_exp_f32 v249, v249
    v_exp_f32 v250, v250
    v_exp_f32 v251, v251
    v_add_f32 v10, v10, v248
    v_mfma_f32_32x32x16_bf16 v[224:239], v[44:47], v[76:79], v[224:239]
    ds_read_b128 v[40:43], v18 offset:8192
    v_max3_f32 v15, v220, v221, v15
    v_max3_f32 v15, v222, v223, v15
    v_sub_f32 v24, v15, v9
    v_cmp_lt_f32 vcc, 0x41000000, v24
    s_nop 0
    s_cmp_lg_u64 vcc, 0
    s_cbranch_scc1 L_up6
L_upr6:
    v_mfma_f32_32x32x16_bf16 v[192:207], v[4:7], v[2:5], v[192:207]
    v_add_f32 v11, v11, v249
    v_cvt_pk_bf16_f32 v188, v248, v249
    v_add_f32 v10, v10, v250
    v_add_f32 v11, v11, v251
    v_cvt_pk_bf16_f32 v189, v250, v251
    s_waitcnt lgkmcnt(3)
    v_mfma_f32_32x32x16_bf16 v[224:239], v[48:51], v[80:83], v[224:239]
    ds_read_b128 v[44:47], v19 offset:8192
    v_exp_f32 v252, v252
    v_exp_f32 v253, v253
    v_exp_f32 v254, v254
    v_exp_f32 v255, v255
    v_add_f32 v10, v10, v252
    v_mfma_f32_32x32x16_bf16 v[224:239], v[52:55], v[84:87], v[224:239]
    ds_read_b128 v[48:51], v20 offset:8192
    v_mfma_f32_32x32x16_bf16 v[208:223], v[4:7], v[2:5], v[208:223]
    v_add_f32 v11, v11, v253
    v_cvt_pk_bf16_f32 v190, v252, v253
    v_add_f32 v10, v10, v254
    v_add_f32 v11, v11, v255
    v_cvt_pk_bf16_f32 v191, v254, v255
    v_mfma_f32_32x32x16_bf16 v[224:239], v[56:59], v[88:91], v[224:239]
    ds_read_b128 v[52:55], v21 offset:8192
    v_exp_f32 v192, v192
    v_exp_f32 v193, v193
    v_exp_f32 v194, v194
    v_exp_f32 v195, v195
    v_add_f32 v10, v10, v192
    v_add_f32 v11, v11, v193
    v_cvt_pk_bf16_f32 v192, v192, v193
    v_add_f32 v10, v10, v194
    v_mfma_f32_32x32x16_bf16 v[224:239], v[60:63], v[92:95], v[224:239]
    ds_read_b128 v[56:59], v22 offset:8192
    v_add_f32 v11, v11, v195
    v_cvt_pk_bf16_f32 v193, v194, v195
    v_exp_f32 v196, v196
    v_exp_f32 v197, v197
    v_exp_f32 v198, v198
    v_exp_f32 v199, v199
    v_add_f32 v10, v10, v196
    v_add_f32 v11, v11, v197
    s_waitcnt lgkmcnt(3)
    v_mfma_f32_32x32x16_bf16 v[240:255], v[32:35], v[64:67], 0
    ds_read_b128 v[60:63], v23 offset:8192
    v_cvt_pk_bf16_f32 v194, v196, v197
    v_add_f32 v10, v10, v198
    v_add_f32 v11, v11, v199
    v_cvt_pk_bf16_f32 v195, v198, v199
    v_exp_f32 v200, v200
    v_exp_f32 v201, v201
    v_exp_f32 v202, v202
    v_exp_f32 v203, v203
    v_mfma_f32_32x32x16_bf16 v[240:255], v[36:39], v[68:71], v[240:255]
    v_add_u32 v16, 98304, v8
    v_add_f32 v10, v10, v200
    v_add_f32 v11, v11, v201
    v_cvt_pk_bf16_f32 v196, v200, v201
    v_add_f32 v10, v10, v202
    v_add_f32 v11, v11, v203
    v_cvt_pk_bf16_f32 v197, v202, v203
    v_exp_f32 v204, v204
    v_exp_f32 v205, v205
    v_mfma_f32_32x32x16_bf16 v[240:255], v[40:43], v[72:75], v[240:255]
    v_xor_b32 v17, 64, v16
    v_exp_f32 v206, v206
    v_exp_f32 v207, v207
    v_add_f32 v10, v10, v204
    v_add_f32 v11, v11, v205
    v_cvt_pk_bf16_f32 v198, v204, v205
    v_add_f32 v10, v10, v206
    v_add_f32 v11, v11, v207
    v_cvt_pk_bf16_f32 v199, v206, v207
    v_mfma_f32_32x32x16_bf16 v[240:255], v[44:47], v[76:79], v[240:255]
    s_waitcnt lgkmcnt(0)
    s_barrier
    ds_read_b64_tr_b16 v[32:33], v16 offset:0
    ds_read_b64_tr_b16 v[34:35], v16 offset:1024
    ds_read_b64_tr_b16 v[36:37], v17 offset:0
    ds_read_b64_tr_b16 v[38:39], v17 offset:1024
    v_exp_f32 v208, v208
    v_exp_f32 v209, v209
    v_exp_f32 v210, v210
    v_exp_f32 v211, v211
    v_add_f32 v10, v10, v208
    v_add_f32 v11, v11, v209
    v_cvt_pk_bf16_f32 v200, v208, v209
    v_add_f32 v10, v10, v210
    v_max3_f32 v15, v224, v225, v15
    v_max3_f32 v15, v226, v227, v15
    v_mfma_f32_32x32x16_bf16 v[240:255], v[48:51], v[80:83], v[240:255]
    ds_read_b64_tr_b16 v[40:41], v16 offset:2048
    ds_read_b64_tr_b16 v[42:43], v16 offset:3072
    v_add_f32 v11, v11, v211
    v_cvt_pk_bf16_f32 v201, v210, v211
    v_exp_f32 v212, v212
    v_exp_f32 v213, v213
    v_exp_f32 v214, v214
    v_exp_f32 v215, v215
    v_add_f32 v10, v10, v212
    v_add_f32 v11, v11, v213
    v_max3_f32 v15, v228, v229, v15
    v_max3_f32 v15, v230, v231, v15
    v_mfma_f32_32x32x16_bf16 v[240:255], v[52:55], v[84:87], v[240:255]
    ds_read_b64_tr_b16 v[44:45], v17 offset:2048
    ds_read_b64_tr_b16 v[46:47], v17 offset:3072
    v_cvt_pk_bf16_f32 v202, v212, v213
    v_add_f32 v10, v10, v214
    v_add_f32 v11, v11, v215
    v_cvt_pk_bf16_f32 v203, v214, v215
    v_exp_f32 v216, v216
    v_exp_f32 v217, v217
    v_exp_f32 v218, v218
    v_exp_f32 v219, v219
    v_max3_f32 v15, v232, v233, v15
    v_mfma_f32_32x32x16_bf16 v[240:255], v[56:59], v[88:91], v[240:255]
    ds_read_b64_tr_b16 v[48:49], v16 offset:4096
    ds_read_b64_tr_b16 v[50:51], v16 offset:5120
    v_add_f32 v10, v10, v216
    v_add_f32 v11, v11, v217
    v_cvt_pk_bf16_f32 v204, v216, v217
    v_add_f32 v10, v10, v218
    v_add_f32 v11, v11, v219
    v_cvt_pk_bf16_f32 v205, v218, v219
    v_exp_f32 v220, v220
    v_exp_f32 v221, v221
    v_max3_f32 v15, v234, v235, v15
    v_max3_f32 v15, v236, v237, v15
    v_mfma_f32_32x32x16_bf16 v[240:255], v[60:63], v[92:95], v[240:255]
    ds_read_b64_tr_b16 v[52:53], v17 offset:4096
    ds_read_b64_tr_b16 v[54:55], v17 offset:5120
    v_exp_f32 v222, v222
    v_exp_f32 v223, v223
    v_add_f32 v10, v10, v220
    v_add_f32 v11, v11, v221
    v_cvt_pk_bf16_f32 v206, v220, v221
    v_add_f32 v10, v10, v222
    v_add_f32 v11, v11, v223
    v_cvt_pk_bf16_f32 v207, v222, v223
    v_max3_f32 v15, v238, v239, v15
    s_nop 0
    v_max3_f32 v15, v240, v241, v15
    v_max3_f32 v15, v242, v243, v15
    v_max3_f32 v15, v244, v245, v15
    v_max3_f32 v15, v246, v247, v15
    v_max3_f32 v15, v248, v249, v15
    v_max3_f32 v15, v250, v251, v15
    v_max3_f32 v15, v252, v253, v15
    v_max3_f32 v15, v254, v255, v15
    v_sub_f32 v24, v15, v9
    v_cmp_lt_f32 vcc, 0x41000000, v24
    s_nop 0
    s_cmp_lg_u64 vcc, 0
    s_cbranch_scc1 L_up7
L_upr7:
    v_mfma_f32_32x32x16_bf16 v[224:239], v[4:7], v[2:5], v[224:239]
    v_mfma_f32_32x32x16_bf16 v[240:255], v[4:7], v[2:5], v[240:255]
    s_cmp_lg_u32 s31, 0
    s_cbranch_scc1 L_fix
L_fixr:
    s_waitcnt lgkmcnt(4)
    v_mfma_f32_32x32x16_bf16 v[64:79], v[32:35], v[96:99], 0
    ds_read_b64_tr_b16 v[56:57], v16 offset:6144
    ds_read_b64_tr_b16 v[58:59], v16 offset:7168
    v_mfma_f32_32x32x16_bf16 v[80:95], v[36:39], v[96:99], 0
    ds_read_b64_tr_b16 v[60:61], v17 offset:6144
    ds_read_b64_tr_b16 v[62:63], v17 offset:7168
    v_mfma_f32_32x32x16_bf16 v[64:79], v[40:43], v[100:103], v[64:79]
    ds_read_b64_tr_b16 v[32:33], v16 offset:8192
    ds_read_b64_tr_b16 v[34:35], v16 offset:9216
    ds_read_b64_tr_b16 v[36:37], v17 offset:8192
    ds_read_b64_tr_b16 v[38:39], v17 offset:9216
    v_mfma_f32_32x32x16_bf16 v[80:95], v[44:47], v[100:103], v[80:95]
    ds_read_b64_tr_b16 v[40:41], v16 offset:10240
    ds_read_b64_tr_b16 v[42:43], v16 offset:11264
    v_exp_f32 v224, v224
    v_exp_f32 v225, v225
    v_exp_f32 v226, v226
    s_waitcnt lgkmcnt(6)
    v_mfma_f32_32x32x16_bf16 v[64:79], v[48:51], v[104:107], v[64:79]
    ds_read_b64_tr_b16 v[44:45], v17 offset:10240
    ds_read_b64_tr_b16 v[46:47], v17 offset:11264
    v_exp_f32 v227, v227
    v_add_f32 v10, v10, v224
    v_mfma_f32_32x32x16_bf16 v[80:95], v[52:55], v[104:107], v[80:95]
    ds_read_b64_tr_b16 v[48:49], v16 offset:12288
    ds_read_b64_tr_b16 v[50:51], v16 offset:13312
    v_add_f32 v11, v11, v225
    v_cvt_pk_bf16_f32 v224, v224, v225
    v_mfma_f32_32x32x16_bf16 v[64:79], v[56:59], v[108:111], v[64:79]
    ds_read_b64_tr_b16 v[52:53], v17 offset:12288
    ds_read_b64_tr_b16 v[54:55], v17 offset:13312
    v_add_f32 v10, v10, v226
    v_add_f32 v11, v11, v227
    v_mfma_f32_32x32x16_bf16 v[80:95], v[60:63], v[108:111], v[80:95]
    ds_read_b64_tr_b16 v[56:57], v16 offset:14336
    ds_read_b64_tr_b16 v[58:59], v16 offset:15360
    v_cvt_pk_bf16_f32 v225, v226, v227
    v_exp_f32 v228, v228
    s_waitcnt lgkmcnt(6)
    v_mfma_f32_32x32x16_bf16 v[64:79], v[32:35], v[112:115], v[64:79]
    ds_read_b64_tr_b16 v[60:61], v17 offset:14336
    ds_read_b64_tr_b16 v[62:63], v17 offset:15360
    v_exp_f32 v229, v229
    v_exp_f32 v230, v230
    v_mfma_f32_32x32x16_bf16 v[80:95], v[36:39], v[112:115], v[80:95]
    v_add_u32 v16, 131072, v8
    v_exp_f32 v231, v231
    v_add_f32 v10, v10, v228
    v_mfma_f32_32x32x16_bf16 v[64:79], v[40:43], v[116:119], v[64:79]
    v_xor_b32 v17, 64, v16
    v_add_f32 v11, v11, v229
    v_cvt_pk_bf16_f32 v226, v228, v229
    v_mfma_f32_32x32x16_bf16 v[80:95], v[44:47], v[116:119], v[80:95]
    s_waitcnt lgkmcnt(0)
    s_barrier
    ds_read_b64_tr_b16 v[32:33], v16 offset:0
    ds_read_b64_tr_b16 v[34:35], v16 offset:1024
    ds_read_b64_tr_b16 v[36:37], v17 offset:0
    ds_read_b64_tr_b16 v[38:39], v17 offset:1024
    v_add_f32 v10, v10, v230
    v_add_f32 v11, v11, v231
    v_mfma_f32_32x32x16_bf16 v[64:79], v[48:51], v[120:123], v[64:79]
    ds_read_b64_tr_b16 v[40:41], v16 offset:2048
    ds_read_b64_tr_b16 v[42:43], v16 offset:3072
    v_cvt_pk_bf16_f32 v227, v230, v231
    v_exp_f32 v232, v232
    v_exp_f32 v233, v233
    v_mfma_f32_32x32x16_bf16 v[80:95], v[52:55], v[120:123], v[80:95]
    ds_read_b64_tr_b16 v[44:45], v17 offset:2048
    ds_read_b64_tr_b16 v[46:47], v17 offset:3072
    v_exp_f32 v234, v234
    v_exp_f32 v235, v235
    v_mfma_f32_32x32x16_bf16 v[64:79], v[56:59], v[124:127], v[64:79]
    ds_read_b64_tr_b16 v[48:49], v16 offset:4096
    ds_read_b64_tr_b16 v[50:51], v16 offset:5120
    v_add_f32 v10, v10, v232
    v_add_f32 v11, v11, v233
    v_mfma_f32_32x32x16_bf16 v[80:95], v[60:63], v[124:127], v[80:95]
    ds_read_b64_tr_b16 v[52:53], v17 offset:4096
    ds_read_b64_tr_b16 v[54:55], v17 offset:5120
    v_cvt_pk_bf16_f32 v228, v232, v233
    v_add_f32 v10, v10, v234
    s_waitcnt lgkmcnt(4)
    v_mfma_f32_32x32x16_bf16 v[64:79], v[32:35], v[128:131], v[64:79]
    ds_read_b64_tr_b16 v[56:57], v16 offset:6144
    ds_read_b64_tr_b16 v[58:59], v16 offset:7168
    v_add_f32 v11, v11, v235
    v_cvt_pk_bf16_f32 v229, v234, v235
    v_mfma_f32_32x32x16_bf16 v[80:95], v[36:39], v[128:131], v[80:95]
    ds_read_b64_tr_b16 v[60:61], v17 offset:6144
    ds_read_b64_tr_b16 v[62:63], v17 offset:7168
    v_exp_f32 v236, v236
    v_exp_f32 v237, v237
    v_mfma_f32_32x32x16_bf16 v[64:79], v[40:43], v[132:135], v[64:79]
    ds_read_b64_tr_b16 v[32:33], v16 offset:8192
    ds_read_b64_tr_b16 v[34:35], v16 offset:9216
    ds_read_b64_tr_b16 v[36:37], v17 offset:8192
    ds_read_b64_tr_b16 v[38:39], v17 offset:9216
    v_exp_f32 v238, v238
    v_exp_f32 v239, v239
    v_mfma_f32_32x32x16_bf16 v[80:95], v[44:47], v[132:135], v[80:95]
    ds_read_b64_tr_b16 v[40:41], v16 offset:10240
    ds_read_b64_tr_b16 v[42:43], v16 offset:11264
    v_add_f32 v10, v10, v236
    v_add_f32 v11, v11, v237
    s_waitcnt lgkmcnt(6)
    v_mfma_f32_32x32x16_bf16 v[64:79], v[48:51], v[136:139], v[64:79]
    ds_read_b64_tr_b16 v[44:45], v17 offset:10240
    ds_read_b64_tr_b16 v[46:47], v17 offset:11264
    v_cvt_pk_bf16_f32 v230, v236, v237
    v_add_f32 v10, v10, v238
    v_mfma_f32_32x32x16_bf16 v[80:95], v[52:55], v[136:139], v[80:95]
    ds_read_b64_tr_b16 v[48:49], v16 offset:12288
    ds_read_b64_tr_b16 v[50:51], v16 offset:13312
    v_add_f32 v11, v11, v239
    v_cvt_pk_bf16_f32 v231, v238, v239
    v_mfma_f32_32x32x16_bf16 v[64:79], v[56:59], v[140:143], v[64:79]
    ds_read_b64_tr_b16 v[52:53], v17 offset:12288
    ds_read_b64_tr_b16 v[54:55], v17 offset:13312
    v_exp_f32 v240, v240
    v_exp_f32 v241, v241
    v_exp_f32 v242, v242
    v_mfma_f32_32x32x16_bf16 v[80:95], v[60:63], v[140:143], v[80:95]
    ds_read_b64_tr_b16 v[56:57], v16 offset:14336
    ds_read_b64_tr_b16 v[58:59], v16 offset:15360
    v_exp_f32 v243, v243
    v_add_f32 v10, v10, v240
    s_waitcnt lgkmcnt(6)
    v_mfma_f32_32x32x16_bf16 v[64:79], v[32:35], v[144:147], v[64:79]
    ds_read_b64_tr_b16 v[60:61], v17 offset:14336
    ds_read_b64_tr_b16 v[62:63], v17 offset:15360
    v_add_f32 v11, v11, v241
    v_cvt_pk_bf16_f32 v232, v240, v241
    v_mfma_f32_32x32x16_bf16 v[80:95], v[36:39], v[144:147], v[80:95]
    v_mov_b32 v16, v8
    v_add_f32 v10, v10, v242
    v_add_f32 v11, v11, v243
    v_mfma_f32_32x32x16_bf16 v[64:79], v[40:43], v[148:151], v[64:79]
    v_xor_b32 v17, 64, v16
    v_cvt_pk_bf16_f32 v233, v242, v243
    v_exp_f32 v244, v244
    v_mfma_f32_32x32x16_bf16 v[80:95], v[44:47], v[148:151], v[80:95]
    s_waitcnt lgkmcnt(0)
    s_barrier
    ds_read_b64_tr_b16 v[32:33], v16 offset:0
    ds_read_b64_tr_b16 v[34:35], v16 offset:1024
    ds_read_b64_tr_b16 v[36:37], v17 offset:0
    ds_read_b64_tr_b16 v[38:39], v17 offset:1024
    v_exp_f32 v245, v245
    v_exp_f32 v246, v246
    v_mfma_f32_32x32x16_bf16 v[64:79], v[48:51], v[152:155], v[64:79]
    ds_read_b64_tr_b16 v[40:41], v16 offset:2048
    ds_read_b64_tr_b16 v[42:43], v16 offset:3072
    v_exp_f32 v247, v247
    v_add_f32 v10, v10, v244
    v_mfma_f32_32x32x16_bf16 v[80:95], v[52:55], v[152:155], v[80:95]
    ds_read_b64_tr_b16 v[44:45], v17 offset:2048
    ds_read_b64_tr_b16 v[46:47], v17 offset:3072
    v_add_f32 v11, v11, v245
    v_cvt_pk_bf16_f32 v234, v244, v245
    v_mfma_f32_32x32x16_bf16 v[64:79], v[56:59], v[156:159], v[64:79]
    ds_read_b64_tr_b16 v[48:49], v16 offset:4096
    ds_read_b64_tr_b16 v[50:51], v16 offset:5120
    v_add_f32 v10, v10, v246
    v_add_f32 v11, v11, v247
    v_mfma_f32_32x32x16_bf16 v[80:95], v[60:63], v[156:159], v[80:95]
    ds_read_b64_tr_b16 v[52:53], v17 offset:4096
    ds_read_b64_tr_b16 v[54:55], v17 offset:5120
    v_cvt_pk_bf16_f32 v235, v246, v247
    v_exp_f32 v248, v248
    v_exp_f32 v249, v249
    s_waitcnt lgkmcnt(4)
    v_mfma_f32_32x32x16_bf16 v[64:79], v[32:35], v[160:163], v[64:79]
    ds_read_b64_tr_b16 v[56:57], v16 offset:6144
    ds_read_b64_tr_b16 v[58:59], v16 offset:7168
    v_exp_f32 v250, v250
    v_exp_f32 v251, v251
    v_mfma_f32_32x32x16_bf16 v[80:95], v[36:39], v[160:163], v[80:95]
    ds_read_b64_tr_b16 v[60:61], v17 offset:6144
    ds_read_b64_tr_b16 v[62:63], v17 offset:7168
    v_add_f32 v10, v10, v248
    v_add_f32 v11, v11, v249
    v_mfma_f32_32x32x16_bf16 v[64:79], v[40:43], v[164:167], v[64:79]
    ds_read_b64_tr_b16 v[32:33], v16 offset:8192
    ds_read_b64_tr_b16 v[34:35], v16 offset:9216
    ds_read_b64_tr_b16 v[36:37], v17 offset:8192
    ds_read_b64_tr_b16 v[38:39], v17 offset:9216
    v_cvt_pk_bf16_f32 v236, v248, v249
    v_add_f32 v10, v10, v250
    v_mfma_f32_32x32x16_bf16 v[80:95], v[44:47], v[164:167], v[80:95]
    ds_read_b64_tr_b16 v[40:41], v16 offset:10240
    ds_read_b64_tr_b16 v[42:43], v16 offset:11264
    v_add_f32 v11, v11, v251
    v_cvt_pk_bf16_f32 v237, v250, v251
    s_waitcnt lgkmcnt(6)
    v_mfma_f32_32x32x16_bf16 v[64:79], v[48:51], v[168:171], v[64:79]
    ds_read_b64_tr_b16 v[44:45], v17 offset:10240
    ds_read_b64_tr_b16 v[46:47], v17 offset:11264
    v_exp_f32 v252, v252
    v_exp_f32 v253, v253
    v_mfma_f32_32x32x16_bf16 v[80:95], v[52:55], v[168:171], v[80:95]
    ds_read_b64_tr_b16 v[48:49], v16 offset:12288
    ds_read_b64_tr_b16 v[50:51], v16 offset:13312
    v_exp_f32 v254, v254
    v_exp_f32 v255, v255
    v_mfma_f32_32x32x16_bf16 v[64:79], v[56:59], v[172:175], v[64:79]
    ds_read_b64_tr_b16 v[52:53], v17 offset:12288
    ds_read_b64_tr_b16 v[54:55], v17 offset:13312
    v_add_f32 v10, v10, v252
    v_add_f32 v11, v11, v253
    v_mfma_f32_32x32x16_bf16 v[80:95], v[60:63], v[172:175], v[80:95]
    ds_read_b64_tr_b16 v[56:57], v16 offset:14336
    ds_read_b64_tr_b16 v[58:59], v16 offset:15360
    v_cvt_pk_bf16_f32 v238, v252, v253
    v_add_f32 v10, v10, v254
    s_waitcnt lgkmcnt(6)
    v_mfma_f32_32x32x16_bf16 v[64:79], v[32:35], v[176:179], v[64:79]
    ds_read_b64_tr_b16 v[60:61], v17 offset:14336
    ds_read_b64_tr_b16 v[62:63], v17 offset:15360
    v_add_f32 v11, v11, v255
    v_cvt_pk_bf16_f32 v239, v254, v255
    v_mfma_f32_32x32x16_bf16 v[80:95], v[36:39], v[176:179], v[80:95]
    v_add_u32 v16, 32768, v8
    v_mfma_f32_32x32x16_bf16 v[64:79], v[40:43], v[180:183], v[64:79]
    v_xor_b32 v17, 64, v16
    v_mfma_f32_32x32x16_bf16 v[80:95], v[44:47], v[180:183], v[80:95]
    s_waitcnt lgkmcnt(0)
    s_barrier
    ds_read_b64_tr_b16 v[32:33], v16 offset:0
    ds_read_b64_tr_b16 v[34:35], v16 offset:1024
    ds_read_b64_tr_b16 v[36:37], v17 offset:0
    ds_read_b64_tr_b16 v[38:39], v17 offset:1024
    v_mfma_f32_32x32x16_bf16 v[64:79], v[48:51], v[184:187], v[64:79]
    ds_read_b64_tr_b16 v[40:41], v16 offset:2048
    ds_read_b64_tr_b16 v[42:43], v16 offset:3072
    v_mfma_f32_32x32x16_bf16 v[80:95], v[52:55], v[184:187], v[80:95]
    ds_read_b64_tr_b16 v[44:45], v17 offset:2048
    ds_read_b64_tr_b16 v[46:47], v17 offset:3072
    v_mfma_f32_32x32x16_bf16 v[64:79], v[56:59], v[188:191], v[64:79]
    ds_read_b64_tr_b16 v[48:49], v16 offset:4096
    ds_read_b64_tr_b16 v[50:51], v16 offset:5120
    v_mfma_f32_32x32x16_bf16 v[80:95], v[60:63], v[188:191], v[80:95]
    ds_read_b64_tr_b16 v[52:53], v17 offset:4096
    ds_read_b64_tr_b16 v[54:55], v17 offset:5120
    s_waitcnt lgkmcnt(4)
    v_mfma_f32_32x32x16_bf16 v[64:79], v[32:35], v[192:195], v[64:79]
    ds_read_b64_tr_b16 v[56:57], v16 offset:6144
    ds_read_b64_tr_b16 v[58:59], v16 offset:7168
    v_mfma_f32_32x32x16_bf16 v[80:95], v[36:39], v[192:195], v[80:95]
    ds_read_b64_tr_b16 v[60:61], v17 offset:6144
    ds_read_b64_tr_b16 v[62:63], v17 offset:7168
    v_mfma_f32_32x32x16_bf16 v[64:79], v[40:43], v[196:199], v[64:79]
    ds_read_b64_tr_b16 v[32:33], v16 offset:8192
    ds_read_b64_tr_b16 v[34:35], v16 offset:9216
    ds_read_b64_tr_b16 v[36:37], v17 offset:8192
    ds_read_b64_tr_b16 v[38:39], v17 offset:9216
    v_mfma_f32_32x32x16_bf16 v[80:95], v[44:47], v[196:199], v[80:95]
    ds_read_b64_tr_b16 v[40:41], v16 offset:10240
    ds_read_b64_tr_b16 v[42:43], v16 offset:11264
    s_waitcnt lgkmcnt(6)
    v_mfma_f32_32x32x16_bf16 v[64:79], v[48:51], v[200:203], v[64:79]
    ds_read_b64_tr_b16 v[44:45], v17 offset:10240
    ds_read_b64_tr_b16 v[46:47], v17 offset:11264
    v_mfma_f32_32x32x16_bf16 v[80:95], v[52:55], v[200:203], v[80:95]
    ds_read_b64_tr_b16 v[48:49], v16 offset:12288
    ds_read_b64_tr_b16 v[50:51], v16 offset:13312
    v_mfma_f32_32x32x16_bf16 v[64:79], v[56:59], v[204:207], v[64:79]
    ds_read_b64_tr_b16 v[52:53], v17 offset:12288
    ds_read_b64_tr_b16 v[54:55], v17 offset:13312
    v_mfma_f32_32x32x16_bf16 v[80:95], v[60:63], v[204:207], v[80:95]
    ds_read_b64_tr_b16 v[56:57], v16 offset:14336
    ds_read_b64_tr_b16 v[58:59], v16 offset:15360
    s_waitcnt lgkmcnt(6)
    v_mfma_f32_32x32x16_bf16 v[64:79], v[32:35], v[224:227], v[64:79]
    ds_read_b64_tr_b16 v[60:61], v17 offset:14336
    ds_read_b64_tr_b16 v[62:63], v17 offset:15360
    v_add_f32 v10, v10, v11
    v_mov_b32 v11, v10
    v_mfma_f32_32x32x16_bf16 v[80:95], v[36:39], v[224:227], v[80:95]
    v_add_u32 v16, 65536, v8
    v_permlane32_swap_b32 v10, v11
    v_mfma_f32_32x32x16_bf16 v[64:79], v[40:43], v[228:231], v[64:79]
    v_xor_b32 v17, 64, v16
    v_add_f32 v10, v10, v11
    v_mfma_f32_32x32x16_bf16 v[80:95], v[44:47], v[228:231], v[80:95]
    s_waitcnt lgkmcnt(0)
    s_barrier
    ds_read_b64_tr_b16 v[32:33], v16 offset:0
    ds_read_b64_tr_b16 v[34:35], v16 offset:1024
    ds_read_b64_tr_b16 v[36:37], v17 offset:0
    ds_read_b64_tr_b16 v[38:39], v17 offset:1024
    v_rcp_f32 v15, v10
    v_mfma_f32_32x32x16_bf16 v[64:79], v[48:51], v[232:235], v[64:79]
    ds_read_b64_tr_b16 v[40:41], v16 offset:2048
    ds_read_b64_tr_b16 v[42:43], v16 offset:3072
    v_mfma_f32_32x32x16_bf16 v[80:95], v[52:55], v[232:235], v[80:95]
    ds_read_b64_tr_b16 v[44:45], v17 offset:2048
    ds_read_b64_tr_b16 v[46:47], v17 offset:3072
    v_mfma_f32_32x32x16_bf16 v[64:79], v[56:59], v[236:239], v[64:79]
    ds_read_b64_tr_b16 v[48:49], v16 offset:4096
    ds_read_b64_tr_b16 v[50:51], v16 offset:5120
    v_mfma_f32_32x32x16_bf16 v[80:95], v[60:63], v[236:239], v[80:95]
    ds_read_b64_tr_b16 v[52:53], v17 offset:4096
    ds_read_b64_tr_b16 v[54:55], v17 offset:5120
    s_waitcnt lgkmcnt(4)
    v_mfma_f32_32x32x16_bf16 v[208:223], v[32:35], v[96:99], 0
    ds_read_b64_tr_b16 v[56:57], v16 offset:6144
    ds_read_b64_tr_b16 v[58:59], v16 offset:7168
    v_mfma_f32_32x32x16_bf16 v[240:255], v[36:39], v[96:99], 0
    ds_read_b64_tr_b16 v[60:61], v17 offset:6144
    ds_read_b64_tr_b16 v[62:63], v17 offset:7168
    v_mfma_f32_32x32x16_bf16 v[208:223], v[40:43], v[100:103], v[208:223]
    ds_read_b64_tr_b16 v[32:33], v16 offset:8192
    ds_read_b64_tr_b16 v[34:35], v16 offset:9216
    ds_read_b64_tr_b16 v[36:37], v17 offset:8192
    ds_read_b64_tr_b16 v[38:39], v17 offset:9216
    v_mul_f32 v64, v15, v64
    v_mul_f32 v65, v15, v65
    v_cvt_pk_bf16_f32 v64, v64, v65
    v_mul_f32 v66, v15, v66
    v_mul_f32 v67, v15, v67
    v_cvt_pk_bf16_f32 v65, v66, v67
    v_mfma_f32_32x32x16_bf16 v[240:255], v[44:47], v[100:103], v[240:255]
    ds_read_b64_tr_b16 v[40:41], v16 offset:10240
    ds_read_b64_tr_b16 v[42:43], v16 offset:11264
    v_mul_f32 v68, v15, v68
    v_mul_f32 v69, v15, v69
    v_cvt_pk_bf16_f32 v66, v68, v69
    v_mul_f32 v70, v15, v70
    v_mul_f32 v71, v15, v71
    v_cvt_pk_bf16_f32 v67, v70, v71
    s_waitcnt lgkmcnt(6)
    v_mfma_f32_32x32x16_bf16 v[208:223], v[48:51], v[104:107], v[208:223]
    ds_read_b64_tr_b16 v[44:45], v17 offset:10240
    ds_read_b64_tr_b16 v[46:47], v17 offset:11264
    v_mul_f32 v72, v15, v72
    v_mul_f32 v73, v15, v73
    v_cvt_pk_bf16_f32 v68, v72, v73
    v_mul_f32 v74, v15, v74
    v_mul_f32 v75, v15, v75
    v_cvt_pk_bf16_f32 v69, v74, v75
    v_mfma_f32_32x32x16_bf16 v[240:255], v[52:55], v[104:107], v[240:255]
    ds_read_b64_tr_b16 v[48:49], v16 offset:12288
    ds_read_b64_tr_b16 v[50:51], v16 offset:13312
    v_mul_f32 v76, v15, v76
    v_mul_f32 v77, v15, v77
    v_cvt_pk_bf16_f32 v70, v76, v77
    v_mul_f32 v78, v15, v78
    v_mul_f32 v79, v15, v79
    v_cvt_pk_bf16_f32 v71, v78, v79
    v_mfma_f32_32x32x16_bf16 v[208:223], v[56:59], v[108:111], v[208:223]
    ds_read_b64_tr_b16 v[52:53], v17 offset:12288
    ds_read_b64_tr_b16 v[54:55], v17 offset:13312
    v_mul_f32 v80, v15, v80
    v_mul_f32 v81, v15, v81
    v_cvt_pk_bf16_f32 v72, v80, v81
    v_mul_f32 v82, v15, v82
    v_mul_f32 v83, v15, v83
    v_cvt_pk_bf16_f32 v73, v82, v83
    v_mfma_f32_32x32x16_bf16 v[240:255], v[60:63], v[108:111], v[240:255]
    ds_read_b64_tr_b16 v[56:57], v16 offset:14336
    ds_read_b64_tr_b16 v[58:59], v16 offset:15360
    v_mul_f32 v84, v15, v84
    v_mul_f32 v85, v15, v85
    v_cvt_pk_bf16_f32 v74, v84, v85
    v_mul_f32 v86, v15, v86
    v_mul_f32 v87, v15, v87
    v_cvt_pk_bf16_f32 v75, v86, v87
    s_waitcnt lgkmcnt(6)
    v_mfma_f32_32x32x16_bf16 v[208:223], v[32:35], v[112:115], v[208:223]
    ds_read_b64_tr_b16 v[60:61], v17 offset:14336
    ds_read_b64_tr_b16 v[62:63], v17 offset:15360
    v_mul_f32 v88, v15, v88
    v_mul_f32 v89, v15, v89
    v_cvt_pk_bf16_f32 v76, v88, v89
    v_mul_f32 v90, v15, v90
    v_mul_f32 v91, v15, v91
    v_cvt_pk_bf16_f32 v77, v90, v91
    v_mfma_f32_32x32x16_bf16 v[240:255], v[36:39], v[112:115], v[240:255]
    v_add_u32 v16, 98304, v8
    v_mul_f32 v92, v15, v92
    v_mul_f32 v93, v15, v93
    v_cvt_pk_bf16_f32 v78, v92, v93
    v_mul_f32 v94, v15, v94
    v_mul_f32 v95, v15, v95
    v_cvt_pk_bf16_f32 v79, v94, v95
    v_mfma_f32_32x32x16_bf16 v[208:223], v[40:43], v[116:119], v[208:223]
    v_xor_b32 v17, 64, v16
    v_xor_b32 v24, 0x2000, v14
    ds_write_b128 v14, v[64:67] offset:0
    ds_write_b128 v14, v[68:71] offset:1024
    ds_write_b128 v14, v[72:75] offset:2048
    ds_write_b128 v14, v[76:79] offset:3072
    v_mfma_f32_32x32x16_bf16 v[240:255], v[44:47], v[116:119], v[240:255]
    s_waitcnt lgkmcnt(0)
    s_barrier
    ds_read_b128 v[80:83], v24 offset:0
    ds_read_b128 v[84:87], v24 offset:1024
    ds_read_b128 v[88:91], v24 offset:2048
    ds_read_b128 v[92:95], v24 offset:3072
    ds_read_b64_tr_b16 v[32:33], v16 offset:0
    ds_read_b64_tr_b16 v[34:35], v16 offset:1024
    ds_read_b64_tr_b16 v[36:37], v17 offset:0
    ds_read_b64_tr_b16 v[38:39], v17 offset:1024
    v_mfma_f32_32x32x16_bf16 v[208:223], v[48:51], v[120:123], v[208:223]
    ds_read_b64_tr_b16 v[40:41], v16 offset:2048
    ds_read_b64_tr_b16 v[42:43], v16 offset:3072
    v_mfma_f32_32x32x16_bf16 v[240:255], v[52:55], v[120:123], v[240:255]
    ds_read_b64_tr_b16 v[44:45], v17 offset:2048
    ds_read_b64_tr_b16 v[46:47], v17 offset:3072
    v_mfma_f32_32x32x16_bf16 v[208:223], v[56:59], v[124:127], v[208:223]
    ds_read_b64_tr_b16 v[48:49], v16 offset:4096
    ds_read_b64_tr_b16 v[50:51], v16 offset:5120
    v_mfma_f32_32x32x16_bf16 v[240:255], v[60:63], v[124:127], v[240:255]
    ds_read_b64_tr_b16 v[52:53], v17 offset:4096
    s_waitcnt lgkmcnt(14)
    ds_read_b64_tr_b16 v[54:55], v17 offset:5120
    s_waitcnt lgkmcnt(4)
    v_mfma_f32_32x32x16_bf16 v[208:223], v[32:35], v[128:131], v[208:223]
    ds_read_b64_tr_b16 v[56:57], v16 offset:6144
    ds_read_b64_tr_b16 v[58:59], v16 offset:7168
    v_mfma_f32_32x32x16_bf16 v[240:255], v[36:39], v[128:131], v[240:255]
    ds_read_b64_tr_b16 v[60:61], v17 offset:6144
    ds_read_b64_tr_b16 v[62:63], v17 offset:7168
    v_mfma_f32_32x32x16_bf16 v[208:223], v[40:43], v[132:135], v[208:223]
    ds_read_b64_tr_b16 v[32:33], v16 offset:8192
    ds_read_b64_tr_b16 v[34:35], v16 offset:9216
    ds_read_b64_tr_b16 v[36:37], v17 offset:8192
    ds_read_b64_tr_b16 v[38:39], v17 offset:9216
    v_mfma_f32_32x32x16_bf16 v[240:255], v[44:47], v[132:135], v[240:255]
    ds_read_b64_tr_b16 v[40:41], v16 offset:10240
    ds_read_b64_tr_b16 v[42:43], v16 offset:11264
    s_waitcnt lgkmcnt(6)
    v_mfma_f32_32x32x16_bf16 v[208:223], v[48:51], v[136:139], v[208:223]
    ds_read_b64_tr_b16 v[44:45], v17 offset:10240
    ds_read_b64_tr_b16 v[46:47], v17 offset:11264
    v_mfma_f32_32x32x16_bf16 v[240:255], v[52:55], v[136:139], v[240:255]
    ds_read_b64_tr_b16 v[48:49], v16 offset:12288
    ds_read_b64_tr_b16 v[50:51], v16 offset:13312
    v_mfma_f32_32x32x16_bf16 v[208:223], v[56:59], v[140:143], v[208:223]
    ds_read_b64_tr_b16 v[52:53], v17 offset:12288
    ds_read_b64_tr_b16 v[54:55], v17 offset:13312
    v_mfma_f32_32x32x16_bf16 v[240:255], v[60:63], v[140:143], v[240:255]
    ds_read_b64_tr_b16 v[56:57], v16 offset:14336
    ds_read_b64_tr_b16 v[58:59], v16 offset:15360
    s_waitcnt lgkmcnt(6)
    v_mfma_f32_32x32x16_bf16 v[208:223], v[32:35], v[144:147], v[208:223]
    ds_read_b64_tr_b16 v[60:61], v17 offset:14336
    ds_read_b64_tr_b16 v[62:63], v17 offset:15360
    v_mfma_f32_32x32x16_bf16 v[240:255], v[36:39], v[144:147], v[240:255]
    v_add_u32 v16, 131072, v8
    v_mfma_f32_32x32x16_bf16 v[208:223], v[40:43], v[148:151], v[208:223]
    v_xor_b32 v17, 64, v16
    v_mfma_f32_32x32x16_bf16 v[240:255], v[44:47], v[148:151], v[240:255]
    s_waitcnt lgkmcnt(0)
    s_barrier
    ds_read_b64_tr_b16 v[32:33], v16 offset:0
    ds_read_b64_tr_b16 v[34:35], v16 offset:1024
    ds_read_b64_tr_b16 v[36:37], v17 offset:0
    ds_read_b64_tr_b16 v[38:39], v17 offset:1024
    v_mfma_f32_32x32x16_bf16 v[208:223], v[48:51], v[152:155], v[208:223]
    ds_read_b64_tr_b16 v[40:41], v16 offset:2048
    ds_read_b64_tr_b16 v[42:43], v16 offset:3072
    v_mfma_f32_32x32x16_bf16 v[240:255], v[52:55], v[152:155], v[240:255]
    ds_read_b64_tr_b16 v[44:45], v17 offset:2048
    ds_read_b64_tr_b16 v[46:47], v17 offset:3072
    v_mfma_f32_32x32x16_bf16 v[208:223], v[56:59], v[156:159], v[208:223]
    ds_read_b64_tr_b16 v[48:49], v16 offset:4096
    ds_read_b64_tr_b16 v[50:51], v16 offset:5120
    v_mfma_f32_32x32x16_bf16 v[240:255], v[60:63], v[156:159], v[240:255]
    ds_read_b64_tr_b16 v[52:53], v17 offset:4096
    ds_read_b64_tr_b16 v[54:55], v17 offset:5120
    s_waitcnt lgkmcnt(4)
    v_mfma_f32_32x32x16_bf16 v[208:223], v[32:35], v[160:163], v[208:223]
    ds_read_b64_tr_b16 v[56:57], v16 offset:6144
    ds_read_b64_tr_b16 v[58:59], v16 offset:7168
    v_add_u32 v14, 0, v14
    v_mfma_f32_32x32x16_bf16 v[240:255], v[36:39], v[160:163], v[240:255]
    ds_read_b64_tr_b16 v[60:61], v17 offset:6144
    ds_read_b64_tr_b16 v[62:63], v17 offset:7168
    v_mfma_f32_32x32x16_bf16 v[208:223], v[40:43], v[164:167], v[208:223]
    ds_read_b64_tr_b16 v[32:33], v16 offset:8192
    ds_read_b64_tr_b16 v[34:35], v16 offset:9216
    ds_read_b64_tr_b16 v[36:37], v17 offset:8192
    ds_read_b64_tr_b16 v[38:39], v17 offset:9216
    v_mfma_f32_32x32x16_bf16 v[240:255], v[44:47], v[164:167], v[240:255]
    ds_read_b64_tr_b16 v[40:41], v16 offset:10240
    ds_read_b64_tr_b16 v[42:43], v16 offset:11264
    s_waitcnt lgkmcnt(6)
    v_mfma_f32_32x32x16_bf16 v[208:223], v[48:51], v[168:171], v[208:223]
    ds_read_b64_tr_b16 v[44:45], v17 offset:10240
    ds_read_b64_tr_b16 v[46:47], v17 offset:11264
    v_mfma_f32_32x32x16_bf16 v[240:255], v[52:55], v[168:171], v[240:255]
    ds_read_b64_tr_b16 v[48:49], v16 offset:12288
    ds_read_b64_tr_b16 v[50:51], v16 offset:13312
    v_mfma_f32_32x32x16_bf16 v[208:223], v[56:59], v[172:175], v[208:223]
    ds_read_b64_tr_b16 v[52:53], v17 offset:12288
    ds_read_b64_tr_b16 v[54:55], v17 offset:13312
    v_mfma_f32_32x32x16_bf16 v[240:255], v[60:63], v[172:175], v[240:255]
    ds_read_b64_tr_b16 v[56:57], v16 offset:14336
    ds_read_b64_tr_b16 v[58:59], v16 offset:15360
    s_waitcnt lgkmcnt(6)
    v_mfma_f32_32x32x16_bf16 v[208:223], v[32:35], v[176:179], v[208:223]
    ds_read_b64_tr_b16 v[60:61], v17 offset:14336
    ds_read_b64_tr_b16 v[62:63], v17 offset:15360
    v_mfma_f32_32x32x16_bf16 v[240:255], v[36:39], v[176:179], v[240:255]
    v_mov_b32 v16, v12
    v_mfma_f32_32x32x16_bf16 v[208:223], v[40:43], v[180:183], v[208:223]
    v_xor_b32 v17, 0x2000, v16
    v_mfma_f32_32x32x16_bf16 v[240:255], v[44:47], v[180:183], v[240:255]
    s_waitcnt lgkmcnt(0)
    s_barrier
    ds_read_b64_tr_b16 v[32:33], v16 offset:0
    ds_read_b64_tr_b16 v[34:35], v16 offset:1024
    ds_read_b64_tr_b16 v[36:37], v16 offset:2048
    ds_read_b64_tr_b16 v[38:39], v16 offset:3072
    v_mfma_f32_32x32x16_bf16 v[208:223], v[48:51], v[184:187], v[208:223]
    ds_read_b64_tr_b16 v[40:41], v16 offset:4096
    ds_read_b64_tr_b16 v[42:43], v16 offset:5120
    v_mfma_f32_32x32x16_bf16 v[240:255], v[52:55], v[184:187], v[240:255]
    ds_read_b64_tr_b16 v[44:45], v16 offset:6144
    ds_read_b64_tr_b16 v[46:47], v16 offset:7168
    v_mfma_f32_32x32x16_bf16 v[208:223], v[56:59], v[188:191], v[208:223]
    ds_read_b64_tr_b16 v[48:49], v17 offset:0
    ds_read_b64_tr_b16 v[50:51], v17 offset:1024
    v_mfma_f32_32x32x16_bf16 v[240:255], v[60:63], v[188:191], v[240:255]
    ds_read_b64_tr_b16 v[52:53], v17 offset:2048
    ds_read_b64_tr_b16 v[54:55], v17 offset:3072
    s_waitcnt lgkmcnt(4)
    v_mfma_f32_32x32x16_bf16 v[96:111], v[32:35], v[64:67], 0
    ds_read_b64_tr_b16 v[56:57], v17 offset:4096
    ds_read_b64_tr_b16 v[58:59], v17 offset:5120
    v_mfma_f32_32x32x16_bf16 v[96:111], v[36:39], v[68:71], v[96:111]
    ds_read_b64_tr_b16 v[60:61], v17 offset:6144
    ds_read_b64_tr_b16 v[62:63], v17 offset:7168
    v_mfma_f32_32x32x16_bf16 v[96:111], v[40:43], v[72:75], v[96:111]
    ds_read_b64_tr_b16 v[32:33], v16 offset:16384
    ds_read_b64_tr_b16 v[34:35], v16 offset:17408
    ds_read_b64_tr_b16 v[36:37], v16 offset:18432
    ds_read_b64_tr_b16 v[38:39], v16 offset:19456
    v_mfma_f32_32x32x16_bf16 v[96:111], v[44:47], v[76:79], v[96:111]
    ds_read_b64_tr_b16 v[40:41], v16 offset:20480
    ds_read_b64_tr_b16 v[42:43], v16 offset:21504
    s_waitcnt lgkmcnt(6)
    v_mfma_f32_32x32x16_bf16 v[96:111], v[48:51], v[80:83], v[96:111]
    ds_read_b64_tr_b16 v[44:45], v16 offset:22528
    ds_read_b64_tr_b16 v[46:47], v16 offset:23552
    v_mfma_f32_32x32x16_bf16 v[96:111], v[52:55], v[84:87], v[96:111]
    ds_read_b64_tr_b16 v[48:49], v17 offset:16384
    ds_read_b64_tr_b16 v[50:51], v17 offset:17408
    v_mfma_f32_32x32x16_bf16 v[96:111], v[56:59], v[88:91], v[96:111]
    ds_read_b64_tr_b16 v[52:53], v17 offset:18432
    ds_read_b64_tr_b16 v[54:55], v17 offset:19456
    v_mfma_f32_32x32x16_bf16 v[96:111], v[60:63], v[92:95], v[96:111]
    ds_read_b64_tr_b16 v[56:57], v17 offset:20480
    ds_read_b64_tr_b16 v[58:59], v17 offset:21504
    s_waitcnt lgkmcnt(6)
    v_mfma_f32_32x32x16_bf16 v[112:127], v[32:35], v[64:67], 0
    ds_read_b64_tr_b16 v[60:61], v17 offset:22528
    ds_read_b64_tr_b16 v[62:63], v17 offset:23552
    v_mfma_f32_32x32x16_bf16 v[112:127], v[36:39], v[68:71], v[112:127]
    v_add_u32 v16, 32768, v8
    v_mfma_f32_32x32x16_bf16 v[112:127], v[40:43], v[72:75], v[112:127]
    v_xor_b32 v17, 64, v16
    v_mfma_f32_32x32x16_bf16 v[112:127], v[44:47], v[76:79], v[112:127]
    s_waitcnt lgkmcnt(0)
    s_barrier
    ds_read_b64_tr_b16 v[32:33], v16 offset:0
    ds_read_b64_tr_b16 v[34:35], v16 offset:1024
    ds_read_b64_tr_b16 v[36:37], v16 offset:2048
    ds_read_b64_tr_b16 v[38:39], v16 offset:3072
    v_cvt_pk_bf16_f32 v96, v96, v97
    v_cvt_pk_bf16_f32 v97, v98, v99
    v_cvt_pk_bf16_f32 v98, v100, v101
    v_mfma_f32_32x32x16_bf16 v[112:127], v[48:51], v[80:83], v[112:127]
    ds_read_b64_tr_b16 v[40:41], v16 offset:4096
    ds_read_b64_tr_b16 v[42:43], v16 offset:5120
    v_cvt_pk_bf16_f32 v99, v102, v103
    v_cvt_pk_bf16_f32 v100, v104, v105
    v_cvt_pk_bf16_f32 v101, v106, v107
    v_mfma_f32_32x32x16_bf16 v[112:127], v[52:55], v[84:87], v[112:127]
    ds_read_b64_tr_b16 v[44:45], v16 offset:6144
    ds_read_b64_tr_b16 v[46:47], v16 offset:7168
    v_cvt_pk_bf16_f32 v102, v108, v109
    v_cvt_pk_bf16_f32 v103, v110, v111
    v_mfma_f32_32x32x16_bf16 v[112:127], v[56:59], v[88:91], v[112:127]
    ds_read_b64_tr_b16 v[48:49], v16 offset:8192
    ds_read_b64_tr_b16 v[50:51], v16 offset:9216
    v_mfma_f32_32x32x16_bf16 v[112:127], v[60:63], v[92:95], v[112:127]
    ds_read_b64_tr_b16 v[52:53], v16 offset:10240
    ds_read_b64_tr_b16 v[54:55], v16 offset:11264
    s_waitcnt lgkmcnt(4)
    v_mfma_f32_32x32x16_bf16 v[208:223], v[32:35], v[192:195], v[208:223]
    ds_read_b64_tr_b16 v[56:57], v16 offset:12288
    ds_read_b64_tr_b16 v[58:59], v16 offset:13312
    v_mfma_f32_32x32x16_bf16 v[208:223], v[36:39], v[196:199], v[208:223]
    ds_read_b64_tr_b16 v[60:61], v16 offset:14336
    ds_read_b64_tr_b16 v[62:63], v16 offset:15360
    v_mfma_f32_32x32x16_bf16 v[208:223], v[40:43], v[200:203], v[208:223]
    ds_read_b64_tr_b16 v[32:33], v17 offset:0
    ds_read_b64_tr_b16 v[34:35], v17 offset:1024
    ds_read_b64_tr_b16 v[36:37], v17 offset:2048
    ds_read_b64_tr_b16 v[38:39], v17 offset:3072
    v_mfma_f32_32x32x16_bf16 v[208:223], v[44:47], v[204:207], v[208:223]
    ds_read_b64_tr_b16 v[40:41], v17 offset:4096
    ds_read_b64_tr_b16 v[42:43], v17 offset:5120
    v_cvt_pk_bf16_f32 v104, v112, v113
    v_cvt_pk_bf16_f32 v105, v114, v115
    v_cvt_pk_bf16_f32 v106, v116, v117
    s_waitcnt lgkmcnt(6)
    v_mfma_f32_32x32x16_bf16 v[208:223], v[48:51], v[224:227], v[208:223]
    ds_read_b64_tr_b16 v[44:45], v17 offset:6144
    ds_read_b64_tr_b16 v[46:47], v17 offset:7168
    v_cvt_pk_bf16_f32 v107, v118, v119
    v_cvt_pk_bf16_f32 v108, v120, v121
    v_cvt_pk_bf16_f32 v109, v122, v123
    v_mfma_f32_32x32x16_bf16 v[208:223], v[52:55], v[228:231], v[208:223]
    ds_read_b64_tr_b16 v[48:49], v17 offset:8192
    ds_read_b64_tr_b16 v[50:51], v17 offset:9216
    v_cvt_pk_bf16_f32 v110, v124, v125
    v_cvt_pk_bf16_f32 v111, v126, v127
    v_mfma_f32_32x32x16_bf16 v[208:223], v[56:59], v[232:235], v[208:223]
    ds_read_b64_tr_b16 v[52:53], v17 offset:10240
    ds_read_b64_tr_b16 v[54:55], v17 offset:11264
    v_mfma_f32_32x32x16_bf16 v[208:223], v[60:63], v[236:239], v[208:223]
    ds_read_b64_tr_b16 v[56:57], v17 offset:12288
    ds_read_b64_tr_b16 v[58:59], v17 offset:13312
    s_waitcnt lgkmcnt(6)
    v_mfma_f32_32x32x16_bf16 v[240:255], v[32:35], v[192:195], v[240:255]
    ds_read_b64_tr_b16 v[60:61], v17 offset:14336
    ds_read_b64_tr_b16 v[62:63], v17 offset:15360
    v_mfma_f32_32x32x16_bf16 v[240:255], v[36:39], v[196:199], v[240:255]
    v_add_u32 v16, 65536, v12
    v_mfma_f32_32x32x16_bf16 v[240:255], v[40:43], v[200:203], v[240:255]
    v_xor_b32 v17, 0x2000, v16
    s_nop 1
    v_mul_f32 v208, v15, v208
    v_mul_f32 v209, v15, v209
    v_cvt_pk_bf16_f32 v208, v208, v209
    v_mfma_f32_32x32x16_bf16 v[240:255], v[44:47], v[204:207], v[240:255]
    s_waitcnt lgkmcnt(0)
    s_barrier
    ds_read_b64_tr_b16 v[32:33], v16 offset:0
    ds_read_b64_tr_b16 v[34:35], v16 offset:1024
    ds_read_b64_tr_b16 v[36:37], v16 offset:2048
    ds_read_b64_tr_b16 v[38:39], v16 offset:3072
    v_mul_f32 v210, v15, v210
    v_mul_f32 v211, v15, v211
    v_cvt_pk_bf16_f32 v209, v210, v211
    v_mfma_f32_32x32x16_bf16 v[240:255], v[48:51], v[224:227], v[240:255]
    ds_read_b64_tr_b16 v[40:41], v16 offset:4096
    ds_read_b64_tr_b16 v[42:43], v16 offset:5120
    v_mul_f32 v212, v15, v212
    v_mul_f32 v213, v15, v213
    v_cvt_pk_bf16_f32 v210, v212, v213
    v_mfma_f32_32x32x16_bf16 v[240:255], v[52:55], v[228:231], v[240:255]
    ds_read_b64_tr_b16 v[44:45], v16 offset:6144
    ds_read_b64_tr_b16 v[46:47], v16 offset:7168
    v_mul_f32 v214, v15, v214
    v_mul_f32 v215, v15, v215
    v_cvt_pk_bf16_f32 v211, v214, v215
    v_mfma_f32_32x32x16_bf16 v[240:255], v[56:59], v[232:235], v[240:255]
    ds_read_b64_tr_b16 v[48:49], v17 offset:0
    ds_read_b64_tr_b16 v[50:51], v17 offset:1024
    v_mul_f32 v216, v15, v216
    v_mul_f32 v217, v15, v217
    v_cvt_pk_bf16_f32 v212, v216, v217
    v_mfma_f32_32x32x16_bf16 v[240:255], v[60:63], v[236:239], v[240:255]
    ds_read_b64_tr_b16 v[52:53], v17 offset:2048
    ds_read_b64_tr_b16 v[54:55], v17 offset:3072
    v_mul_f32 v218, v15, v218
    v_mul_f32 v219, v15, v219
    v_cvt_pk_bf16_f32 v213, v218, v219
    s_waitcnt lgkmcnt(4)
    v_mfma_f32_32x32x16_bf16 v[160:175], v[32:35], v[64:67], 0
    ds_read_b64_tr_b16 v[56:57], v17 offset:4096
    ds_read_b64_tr_b16 v[58:59], v17 offset:5120
    v_mul_f32 v220, v15, v220
    v_mul_f32 v221, v15, v221
    v_cvt_pk_bf16_f32 v214, v220, v221
    v_mfma_f32_32x32x16_bf16 v[160:175], v[36:39], v[68:71], v[160:175]
    ds_read_b64_tr_b16 v[60:61], v17 offset:6144
    ds_read_b64_tr_b16 v[62:63], v17 offset:7168
    v_mul_f32 v222, v15, v222
    v_mul_f32 v223, v15, v223
    v_cvt_pk_bf16_f32 v215, v222, v223
    v_mfma_f32_32x32x16_bf16 v[160:175], v[40:43], v[72:75], v[160:175]
    ds_read_b64_tr_b16 v[32:33], v16 offset:16384
    ds_read_b64_tr_b16 v[34:35], v16 offset:17408
    ds_read_b64_tr_b16 v[36:37], v16 offset:18432
    ds_read_b64_tr_b16 v[38:39], v16 offset:19456
    v_mul_f32 v240, v15, v240
    v_mul_f32 v241, v15, v241
    v_cvt_pk_bf16_f32 v216, v240, v241
    v_mul_f32 v242, v15, v242
    v_mfma_f32_32x32x16_bf16 v[160:175], v[44:47], v[76:79], v[160:175]
    ds_read_b64_tr_b16 v[40:41], v16 offset:20480
    ds_read_b64_tr_b16 v[42:43], v16 offset:21504
    v_mul_f32 v243, v15, v243
    v_cvt_pk_bf16_f32 v217, v242, v243
    v_mul_f32 v244, v15, v244
    v_mul_f32 v245, v15, v245
    s_waitcnt lgkmcnt(6)
    v_mfma_f32_32x32x16_bf16 v[160:175], v[48:51], v[80:83], v[160:175]
    ds_read_b64_tr_b16 v[44:45], v16 offset:22528
    ds_read_b64_tr_b16 v[46:47], v16 offset:23552
    v_cvt_pk_bf16_f32 v218, v244, v245
    v_mul_f32 v246, v15, v246
    v_mul_f32 v247, v15, v247
    v_cvt_pk_bf16_f32 v219, v246, v247
    v_mfma_f32_32x32x16_bf16 v[160:175], v[52:55], v[84:87], v[160:175]
    ds_read_b64_tr_b16 v[48:49], v17 offset:16384
    ds_read_b64_tr_b16 v[50:51], v17 offset:17408
    v_mul_f32 v248, v15, v248
    v_mul_f32 v249, v15, v249
    v_cvt_pk_bf16_f32 v220, v248, v249
    v_mul_f32 v250, v15, v250
    v_mfma_f32_32x32x16_bf16 v[160:175], v[56:59], v[88:91], v[160:175]
    ds_read_b64_tr_b16 v[52:53], v17 offset:18432
    ds_read_b64_tr_b16 v[54:55], v17 offset:19456
    v_mul_f32 v251, v15, v251
    v_cvt_pk_bf16_f32 v221, v250, v251
    v_mul_f32 v252, v15, v252
    v_mul_f32 v253, v15, v253
    v_mfma_f32_32x32x16_bf16 v[160:175], v[60:63], v[92:95], v[160:175]
    ds_read_b64_tr_b16 v[56:57], v17 offset:20480
    ds_read_b64_tr_b16 v[58:59], v17 offset:21504
    v_cvt_pk_bf16_f32 v222, v252, v253
    v_mul_f32 v254, v15, v254
    v_mul_f32 v255, v15, v255
    v_cvt_pk_bf16_f32 v223, v254, v255
    s_waitcnt lgkmcnt(6)
    v_mfma_f32_32x32x16_bf16 v[160:175], v[32:35], v[208:211], v[160:175]
    ds_read_b64_tr_b16 v[60:61], v17 offset:22528
    ds_read_b64_tr_b16 v[62:63], v17 offset:23552
    v_mfma_f32_32x32x16_bf16 v[160:175], v[36:39], v[212:215], v[160:175]
    v_add_u32 v16, 98304, v12
    v_mfma_f32_32x32x16_bf16 v[160:175], v[40:43], v[216:219], v[160:175]
    v_xor_b32 v17, 0x2000, v16
    v_xor_b32 v24, 0x2000, v14
    ds_write_b128 v14, v[208:211] offset:0
    ds_write_b128 v14, v[212:215] offset:1024
    ds_write_b128 v14, v[216:219] offset:2048
    ds_write_b128 v14, v[220:223] offset:3072
    v_mfma_f32_32x32x16_bf16 v[160:175], v[44:47], v[220:223], v[160:175]
    s_waitcnt lgkmcnt(0)
    s_barrier
    ds_read_b128 v[192:195], v24 offset:0
    ds_read_b128 v[196:199], v24 offset:1024
    ds_read_b128 v[200:203], v24 offset:2048
    ds_read_b128 v[204:207], v24 offset:3072
    ds_read_b64_tr_b16 v[32:33], v16 offset:0
    ds_read_b64_tr_b16 v[34:35], v16 offset:1024
    ds_read_b64_tr_b16 v[36:37], v16 offset:2048
    ds_read_b64_tr_b16 v[38:39], v16 offset:3072
    s_waitcnt lgkmcnt(4)
    v_mfma_f32_32x32x16_bf16 v[160:175], v[48:51], v[192:195], v[160:175]
    ds_read_b64_tr_b16 v[40:41], v16 offset:4096
    ds_read_b64_tr_b16 v[42:43], v16 offset:5120
    v_mfma_f32_32x32x16_bf16 v[160:175], v[52:55], v[196:199], v[160:175]
    ds_read_b64_tr_b16 v[44:45], v16 offset:6144
    ds_read_b64_tr_b16 v[46:47], v16 offset:7168
    v_mfma_f32_32x32x16_bf16 v[160:175], v[56:59], v[200:203], v[160:175]
    ds_read_b64_tr_b16 v[48:49], v17 offset:0
    ds_read_b64_tr_b16 v[50:51], v17 offset:1024
    v_mfma_f32_32x32x16_bf16 v[160:175], v[60:63], v[204:207], v[160:175]
    ds_read_b64_tr_b16 v[52:53], v17 offset:2048
    ds_read_b64_tr_b16 v[54:55], v17 offset:3072
    s_waitcnt lgkmcnt(4)
    v_mfma_f32_32x32x16_bf16 v[176:191], v[32:35], v[64:67], 0
    ds_read_b64_tr_b16 v[56:57], v17 offset:4096
    ds_read_b64_tr_b16 v[58:59], v17 offset:5120
    v_mfma_f32_32x32x16_bf16 v[176:191], v[36:39], v[68:71], v[176:191]
    ds_read_b64_tr_b16 v[60:61], v17 offset:6144
    ds_read_b64_tr_b16 v[62:63], v17 offset:7168
    v_mfma_f32_32x32x16_bf16 v[176:191], v[40:43], v[72:75], v[176:191]
    ds_read_b64_tr_b16 v[32:33], v16 offset:16384
    ds_read_b64_tr_b16 v[34:35], v16 offset:17408
    ds_read_b64_tr_b16 v[36:37], v16 offset:18432
    ds_read_b64_tr_b16 v[38:39], v16 offset:19456
    v_cvt_pk_bf16_f32 v160, v160, v161
    v_cvt_pk_bf16_f32 v161, v162, v163
    v_cvt_pk_bf16_f32 v162, v164, v165
    v_mfma_f32_32x32x16_bf16 v[176:191], v[44:47], v[76:79], v[176:191]
    ds_read_b64_tr_b16 v[40:41], v16 offset:20480
    ds_read_b64_tr_b16 v[42:43], v16 offset:21504
    v_cvt_pk_bf16_f32 v163, v166, v167
    v_cvt_pk_bf16_f32 v164, v168, v169
    v_cvt_pk_bf16_f32 v165, v170, v171
    s_waitcnt lgkmcnt(6)
    v_mfma_f32_32x32x16_bf16 v[176:191], v[48:51], v[80:83], v[176:191]
    ds_read_b64_tr_b16 v[44:45], v16 offset:22528
    ds_read_b64_tr_b16 v[46:47], v16 offset:23552
    v_cvt_pk_bf16_f32 v166, v172, v173
    v_cvt_pk_bf16_f32 v167, v174, v175
    v_mfma_f32_32x32x16_bf16 v[176:191], v[52:55], v[84:87], v[176:191]
    ds_read_b64_tr_b16 v[48:49], v17 offset:16384
    ds_read_b64_tr_b16 v[50:51], v17 offset:17408
    v_mfma_f32_32x32x16_bf16 v[176:191], v[56:59], v[88:91], v[176:191]
    ds_read_b64_tr_b16 v[52:53], v17 offset:18432
    ds_read_b64_tr_b16 v[54:55], v17 offset:19456
    v_mfma_f32_32x32x16_bf16 v[176:191], v[60:63], v[92:95], v[176:191]
    ds_read_b64_tr_b16 v[56:57], v17 offset:20480
    ds_read_b64_tr_b16 v[58:59], v17 offset:21504
    s_waitcnt lgkmcnt(6)
    v_mfma_f32_32x32x16_bf16 v[176:191], v[32:35], v[208:211], v[176:191]
    ds_read_b64_tr_b16 v[60:61], v17 offset:22528
    ds_read_b64_tr_b16 v[62:63], v17 offset:23552
    v_mfma_f32_32x32x16_bf16 v[176:191], v[36:39], v[212:215], v[176:191]
    v_add_u32 v16, 131072, v12
    v_mfma_f32_32x32x16_bf16 v[176:191], v[40:43], v[216:219], v[176:191]
    v_xor_b32 v17, 0x2000, v16
    v_mfma_f32_32x32x16_bf16 v[176:191], v[44:47], v[220:223], v[176:191]
    s_waitcnt lgkmcnt(0)
    s_barrier
    ds_read_b64_tr_b16 v[32:33], v16 offset:0
    ds_read_b64_tr_b16 v[34:35], v16 offset:1024
    ds_read_b64_tr_b16 v[36:37], v16 offset:2048
    ds_read_b64_tr_b16 v[38:39], v16 offset:3072
    v_mfma_f32_32x32x16_bf16 v[176:191], v[48:51], v[192:195], v[176:191]
    ds_read_b64_tr_b16 v[40:41], v16 offset:4096
    ds_read_b64_tr_b16 v[42:43], v16 offset:5120
    v_mfma_f32_32x32x16_bf16 v[176:191], v[52:55], v[196:199], v[176:191]
    ds_read_b64_tr_b16 v[44:45], v16 offset:6144
    ds_read_b64_tr_b16 v[46:47], v16 offset:7168
    v_mfma_f32_32x32x16_bf16 v[176:191], v[56:59], v[200:203], v[176:191]
    ds_read_b64_tr_b16 v[48:49], v17 offset:0
    ds_read_b64_tr_b16 v[50:51], v17 offset:1024
    v_mfma_f32_32x32x16_bf16 v[176:191], v[60:63], v[204:207], v[176:191]
    ds_read_b64_tr_b16 v[52:53], v17 offset:2048
    ds_read_b64_tr_b16 v[54:55], v17 offset:3072
    s_waitcnt lgkmcnt(4)
    v_mfma_f32_32x32x16_bf16 v[224:239], v[32:35], v[64:67], 0
    ds_read_b64_tr_b16 v[56:57], v17 offset:4096
    ds_read_b64_tr_b16 v[58:59], v17 offset:5120
    v_mfma_f32_32x32x16_bf16 v[224:239], v[36:39], v[68:71], v[224:239]
    ds_read_b64_tr_b16 v[60:61], v17 offset:6144
    ds_read_b64_tr_b16 v[62:63], v17 offset:7168
    v_mfma_f32_32x32x16_bf16 v[224:239], v[40:43], v[72:75], v[224:239]
    ds_read_b64_tr_b16 v[32:33], v16 offset:16384
    ds_read_b64_tr_b16 v[34:35], v16 offset:17408
    ds_read_b64_tr_b16 v[36:37], v16 offset:18432
    ds_read_b64_tr_b16 v[38:39], v16 offset:19456
    v_cvt_pk_bf16_f32 v176, v176, v177
    v_cvt_pk_bf16_f32 v177, v178, v179
    v_cvt_pk_bf16_f32 v178, v180, v181
    v_mfma_f32_32x32x16_bf16 v[224:239], v[44:47], v[76:79], v[224:239]
    ds_read_b64_tr_b16 v[40:41], v16 offset:20480
    ds_read_b64_tr_b16 v[42:43], v16 offset:21504
    v_cvt_pk_bf16_f32 v179, v182, v183
    v_cvt_pk_bf16_f32 v180, v184, v185
    v_cvt_pk_bf16_f32 v181, v186, v187
    s_waitcnt lgkmcnt(6)
    v_mfma_f32_32x32x16_bf16 v[224:239], v[48:51], v[80:83], v[224:239]
    ds_read_b64_tr_b16 v[44:45], v16 offset:22528
    ds_read_b64_tr_b16 v[46:47], v16 offset:23552
    v_cvt_pk_bf16_f32 v182, v188, v189
    v_cvt_pk_bf16_f32 v183, v190, v191
    v_mfma_f32_32x32x16_bf16 v[224:239], v[52:55], v[84:87], v[224:239]
    ds_read_b64_tr_b16 v[48:49], v17 offset:16384
    ds_read_b64_tr_b16 v[50:51], v17 offset:17408
    v_mfma_f32_32x32x16_bf16 v[224:239], v[56:59], v[88:91], v[224:239]
    ds_read_b64_tr_b16 v[52:53], v17 offset:18432
    ds_read_b64_tr_b16 v[54:55], v17 offset:19456
    v_mfma_f32_32x32x16_bf16 v[224:239], v[60:63], v[92:95], v[224:239]
    ds_read_b64_tr_b16 v[56:57], v17 offset:20480
    ds_read_b64_tr_b16 v[58:59], v17 offset:21504
    s_waitcnt lgkmcnt(6)
    v_mfma_f32_32x32x16_bf16 v[224:239], v[32:35], v[208:211], v[224:239]
    ds_read_b64_tr_b16 v[60:61], v17 offset:22528
    ds_read_b64_tr_b16 v[62:63], v17 offset:23552
    v_mfma_f32_32x32x16_bf16 v[224:239], v[36:39], v[212:215], v[224:239]
    v_mov_b32 v16, v12
    v_mfma_f32_32x32x16_bf16 v[224:239], v[40:43], v[216:219], v[224:239]
    v_xor_b32 v17, 0x2000, v16
    v_mfma_f32_32x32x16_bf16 v[224:239], v[44:47], v[220:223], v[224:239]
    s_waitcnt lgkmcnt(0)
    s_barrier
    ds_read_b64_tr_b16 v[32:33], v16 offset:0
    ds_read_b64_tr_b16 v[34:35], v16 offset:1024
    ds_read_b64_tr_b16 v[36:37], v16 offset:2048
    ds_read_b64_tr_b16 v[38:39], v16 offset:3072
    v_mfma_f32_32x32x16_bf16 v[224:239], v[48:51], v[192:195], v[224:239]
    ds_read_b64_tr_b16 v[40:41], v16 offset:4096
    ds_read_b64_tr_b16 v[42:43], v16 offset:5120
    v_mfma_f32_32x32x16_bf16 v[224:239], v[52:55], v[196:199], v[224:239]
    ds_read_b64_tr_b16 v[44:45], v16 offset:6144
    ds_read_b64_tr_b16 v[46:47], v16 offset:7168
    v_mfma_f32_32x32x16_bf16 v[224:239], v[56:59], v[200:203], v[224:239]
    ds_read_b64_tr_b16 v[48:49], v17 offset:0
    ds_read_b64_tr_b16 v[50:51], v17 offset:1024
    v_mfma_f32_32x32x16_bf16 v[224:239], v[60:63], v[204:207], v[224:239]
    ds_read_b64_tr_b16 v[52:53], v17 offset:2048
    ds_read_b64_tr_b16 v[54:55], v17 offset:3072
    s_waitcnt lgkmcnt(4)
    v_mfma_f32_32x32x16_bf16 v[240:255], v[32:35], v[64:67], 0
    ds_read_b64_tr_b16 v[56:57], v17 offset:4096
    ds_read_b64_tr_b16 v[58:59], v17 offset:5120
    v_mfma_f32_32x32x16_bf16 v[240:255], v[36:39], v[68:71], v[240:255]
    ds_read_b64_tr_b16 v[60:61], v17 offset:6144
    ds_read_b64_tr_b16 v[62:63], v17 offset:7168
    v_mfma_f32_32x32x16_bf16 v[240:255], v[40:43], v[72:75], v[240:255]
    ds_read_b64_tr_b16 v[32:33], v16 offset:16384
    ds_read_b64_tr_b16 v[34:35], v16 offset:17408
    ds_read_b64_tr_b16 v[36:37], v16 offset:18432
    ds_read_b64_tr_b16 v[38:39], v16 offset:19456
    v_cvt_pk_bf16_f32 v224, v224, v225
    v_cvt_pk_bf16_f32 v225, v226, v227
    v_cvt_pk_bf16_f32 v226, v228, v229
    v_mfma_f32_32x32x16_bf16 v[240:255], v[44:47], v[76:79], v[240:255]
    ds_read_b64_tr_b16 v[40:41], v16 offset:20480
    ds_read_b64_tr_b16 v[42:43], v16 offset:21504
    v_cvt_pk_bf16_f32 v227, v230, v231
    v_cvt_pk_bf16_f32 v228, v232, v233
    v_cvt_pk_bf16_f32 v229, v234, v235
    s_waitcnt lgkmcnt(6)
    v_mfma_f32_32x32x16_bf16 v[240:255], v[48:51], v[80:83], v[240:255]
    ds_read_b64_tr_b16 v[44:45], v16 offset:22528
    ds_read_b64_tr_b16 v[46:47], v16 offset:23552
    v_cvt_pk_bf16_f32 v230, v236, v237
    v_cvt_pk_bf16_f32 v231, v238, v239
    v_mfma_f32_32x32x16_bf16 v[240:255], v[52:55], v[84:87], v[240:255]
    ds_read_b64_tr_b16 v[48:49], v17 offset:16384
    ds_read_b64_tr_b16 v[50:51], v17 offset:17408
    v_mfma_f32_32x32x16_bf16 v[240:255], v[56:59], v[88:91], v[240:255]
    ds_read_b64_tr_b16 v[52:53], v17 offset:18432
    ds_read_b64_tr_b16 v[54:55], v17 offset:19456
    v_mfma_f32_32x32x16_bf16 v[240:255], v[60:63], v[92:95], v[240:255]
    ds_read_b64_tr_b16 v[56:57], v17 offset:20480
    ds_read_b64_tr_b16 v[58:59], v17 offset:21504
    s_waitcnt lgkmcnt(6)
    v_mfma_f32_32x32x16_bf16 v[240:255], v[32:35], v[208:211], v[240:255]
    ds_read_b64_tr_b16 v[60:61], v17 offset:22528
    ds_read_b64_tr_b16 v[62:63], v17 offset:23552
    v_mfma_f32_32x32x16_bf16 v[240:255], v[36:39], v[212:215], v[240:255]
    v_add_u32 v16, 65536, v12
    s_mov_b32 s73, 0
    buffer_store_dwordx4 v[160:163], v13, s[60:63], s73 offen offset:0 sc1
    v_mfma_f32_32x32x16_bf16 v[240:255], v[40:43], v[216:219], v[240:255]
    v_xor_b32 v17, 0x2000, v16
    v_mfma_f32_32x32x16_bf16 v[240:255], v[44:47], v[220:223], v[240:255]
    s_waitcnt lgkmcnt(0)
    s_barrier
    ds_read_b64_tr_b16 v[32:33], v16 offset:0
    ds_read_b64_tr_b16 v[34:35], v16 offset:1024
    ds_read_b64_tr_b16 v[36:37], v16 offset:2048
    ds_read_b64_tr_b16 v[38:39], v16 offset:3072
    s_mov_b32 s73, 0
    buffer_store_dwordx4 v[164:167], v13, s[60:63], s73 offen offset:1024 sc1
    v_mfma_f32_32x32x16_bf16 v[240:255], v[48:51], v[192:195], v[240:255]
    ds_read_b64_tr_b16 v[40:41], v16 offset:4096
    ds_read_b64_tr_b16 v[42:43], v16 offset:5120
    v_mfma_f32_32x32x16_bf16 v[240:255], v[52:55], v[196:199], v[240:255]
    ds_read_b64_tr_b16 v[44:45], v16 offset:6144
    ds_read_b64_tr_b16 v[46:47], v16 offset:7168
    s_mov_b32 s73, 8192
    buffer_store_dwordx4 v[176:179], v13, s[60:63], s73 offen offset:0 sc1
    v_mfma_f32_32x32x16_bf16 v[240:255], v[56:59], v[200:203], v[240:255]
    ds_read_b64_tr_b16 v[48:49], v17 offset:0
    ds_read_b64_tr_b16 v[50:51], v17 offset:1024
    v_mfma_f32_32x32x16_bf16 v[240:255], v[60:63], v[204:207], v[240:255]
    ds_read_b64_tr_b16 v[52:53], v17 offset:2048
    ds_read_b64_tr_b16 v[54:55], v17 offset:3072
    s_mov_b32 s73, 8192
    buffer_store_dwordx4 v[180:183], v13, s[60:63], s73 offen offset:1024 sc1
    s_waitcnt lgkmcnt(4)
    v_mfma_f32_32x32x16_bf16 v[160:175], v[32:35], v[64:67], 0
    ds_read_b64_tr_b16 v[56:57], v17 offset:4096
    ds_read_b64_tr_b16 v[58:59], v17 offset:5120
    v_mfma_f32_32x32x16_bf16 v[160:175], v[36:39], v[68:71], v[160:175]
    ds_read_b64_tr_b16 v[60:61], v17 offset:6144
    ds_read_b64_tr_b16 v[62:63], v17 offset:7168
    v_mfma_f32_32x32x16_bf16 v[160:175], v[40:43], v[72:75], v[160:175]
    ds_read_b64_tr_b16 v[32:33], v16 offset:16384
    ds_read_b64_tr_b16 v[34:35], v16 offset:17408
    ds_read_b64_tr_b16 v[36:37], v16 offset:18432
    ds_read_b64_tr_b16 v[38:39], v16 offset:19456
    v_cvt_pk_bf16_f32 v240, v240, v241
    v_cvt_pk_bf16_f32 v241, v242, v243
    v_cvt_pk_bf16_f32 v242, v244, v245
    v_mfma_f32_32x32x16_bf16 v[160:175], v[44:47], v[76:79], v[160:175]
    ds_read_b64_tr_b16 v[40:41], v16 offset:20480
    ds_read_b64_tr_b16 v[42:43], v16 offset:21504
    v_cvt_pk_bf16_f32 v243, v246, v247
    s_mov_b32 s73, 24576
    s_waitcnt lgkmcnt(6)
    v_mfma_f32_32x32x16_bf16 v[160:175], v[48:51], v[80:83], v[160:175]
    ds_read_b64_tr_b16 v[44:45], v16 offset:22528
    ds_read_b64_tr_b16 v[46:47], v16 offset:23552
    buffer_store_dwordx4 v[240:243], v13, s[60:63], s73 offen offset:0 sc1
    v_cvt_pk_bf16_f32 v244, v248, v249
    v_mfma_f32_32x32x16_bf16 v[160:175], v[52:55], v[84:87], v[160:175]
    ds_read_b64_tr_b16 v[48:49], v17 offset:16384
    ds_read_b64_tr_b16 v[50:51], v17 offset:17408
    v_cvt_pk_bf16_f32 v245, v250, v251
    v_cvt_pk_bf16_f32 v246, v252, v253
    v_mfma_f32_32x32x16_bf16 v[160:175], v[56:59], v[88:91], v[160:175]
    ds_read_b64_tr_b16 v[52:53], v17 offset:18432
    ds_read_b64_tr_b16 v[54:55], v17 offset:19456
    v_cvt_pk_bf16_f32 v247, v254, v255
    buffer_store_dwordx4 v[244:247], v13, s[60:63], s73 offen offset:1024 sc1
    v_mfma_f32_32x32x16_bf16 v[160:175], v[60:63], v[92:95], v[160:175]
    ds_read_b64_tr_b16 v[56:57], v17 offset:20480
    ds_read_b64_tr_b16 v[58:59], v17 offset:21504
    s_waitcnt lgkmcnt(6)
    v_mfma_f32_32x32x16_bf16 v[160:175], v[32:35], v[208:211], v[160:175]
    ds_read_b64_tr_b16 v[60:61], v17 offset:22528
    ds_read_b64_tr_b16 v[62:63], v17 offset:23552
    v_mfma_f32_32x32x16_bf16 v[160:175], v[36:39], v[212:215], v[160:175]
    v_add_u32 v16, 32768, v12
    s_mov_b32 s73, 16384
    buffer_store_dwordx4 v[224:227], v13, s[60:63], s73 offen offset:0 sc1
    v_mfma_f32_32x32x16_bf16 v[160:175], v[40:43], v[216:219], v[160:175]
    v_xor_b32 v17, 0x2000, v16
    v_mfma_f32_32x32x16_bf16 v[160:175], v[44:47], v[220:223], v[160:175]
    s_waitcnt lgkmcnt(0)
    s_barrier
    ds_read_b64_tr_b16 v[32:33], v16 offset:0
    ds_read_b64_tr_b16 v[34:35], v16 offset:1024
    ds_read_b64_tr_b16 v[36:37], v16 offset:2048
    ds_read_b64_tr_b16 v[38:39], v16 offset:3072
    s_mov_b32 s73, 16384
    buffer_store_dwordx4 v[228:231], v13, s[60:63], s73 offen offset:1024 sc1
    v_mfma_f32_32x32x16_bf16 v[160:175], v[48:51], v[192:195], v[160:175]
    ds_read_b64_tr_b16 v[40:41], v16 offset:4096
    ds_read_b64_tr_b16 v[42:43], v16 offset:5120
    v_mfma_f32_32x32x16_bf16 v[160:175], v[52:55], v[196:199], v[160:175]
    ds_read_b64_tr_b16 v[44:45], v16 offset:6144
    ds_read_b64_tr_b16 v[46:47], v16 offset:7168
    v_mfma_f32_32x32x16_bf16 v[160:175], v[56:59], v[200:203], v[160:175]
    ds_read_b64_tr_b16 v[48:49], v17 offset:0
    ds_read_b64_tr_b16 v[50:51], v17 offset:1024
    v_mfma_f32_32x32x16_bf16 v[160:175], v[60:63], v[204:207], v[160:175]
    ds_read_b64_tr_b16 v[52:53], v17 offset:2048
    ds_read_b64_tr_b16 v[54:55], v17 offset:3072
    s_waitcnt lgkmcnt(4)
    v_mfma_f32_32x32x16_bf16 v[176:191], v[32:35], v[64:67], 0
    ds_read_b64_tr_b16 v[56:57], v17 offset:4096
    ds_read_b64_tr_b16 v[58:59], v17 offset:5120
    v_mfma_f32_32x32x16_bf16 v[176:191], v[36:39], v[68:71], v[176:191]
    ds_read_b64_tr_b16 v[60:61], v17 offset:6144
    ds_read_b64_tr_b16 v[62:63], v17 offset:7168
    v_mfma_f32_32x32x16_bf16 v[176:191], v[40:43], v[72:75], v[176:191]
    ds_read_b64_tr_b16 v[32:33], v16 offset:16384
    ds_read_b64_tr_b16 v[34:35], v16 offset:17408
    ds_read_b64_tr_b16 v[36:37], v16 offset:18432
    ds_read_b64_tr_b16 v[38:39], v16 offset:19456
    v_cvt_pk_bf16_f32 v160, v160, v161
    v_cvt_pk_bf16_f32 v161, v162, v163
    v_cvt_pk_bf16_f32 v162, v164, v165
    v_mfma_f32_32x32x16_bf16 v[176:191], v[44:47], v[76:79], v[176:191]
    ds_read_b64_tr_b16 v[40:41], v16 offset:20480
    ds_read_b64_tr_b16 v[42:43], v16 offset:21504
    v_cvt_pk_bf16_f32 v163, v166, v167
    s_mov_b32 s73, 32768
    s_waitcnt lgkmcnt(6)
    v_mfma_f32_32x32x16_bf16 v[176:191], v[48:51], v[80:83], v[176:191]
    ds_read_b64_tr_b16 v[44:45], v16 offset:22528
    ds_read_b64_tr_b16 v[46:47], v16 offset:23552
    buffer_store_dwordx4 v[160:163], v13, s[60:63], s73 offen offset:0 sc1
    v_cvt_pk_bf16_f32 v164, v168, v169
    v_mfma_f32_32x32x16_bf16 v[176:191], v[52:55], v[84:87], v[176:191]
    ds_read_b64_tr_b16 v[48:49], v17 offset:16384
    ds_read_b64_tr_b16 v[50:51], v17 offset:17408
    v_cvt_pk_bf16_f32 v165, v170, v171
    v_cvt_pk_bf16_f32 v166, v172, v173
    v_mfma_f32_32x32x16_bf16 v[176:191], v[56:59], v[88:91], v[176:191]
    ds_read_b64_tr_b16 v[52:53], v17 offset:18432
    ds_read_b64_tr_b16 v[54:55], v17 offset:19456
    v_cvt_pk_bf16_f32 v167, v174, v175
    buffer_store_dwordx4 v[164:167], v13, s[60:63], s73 offen offset:1024 sc1
    v_mfma_f32_32x32x16_bf16 v[176:191], v[60:63], v[92:95], v[176:191]
    ds_read_b64_tr_b16 v[56:57], v17 offset:20480
    ds_read_b64_tr_b16 v[58:59], v17 offset:21504
    s_waitcnt lgkmcnt(6)
    v_mfma_f32_32x32x16_bf16 v[176:191], v[32:35], v[208:211], v[176:191]
    ds_read_b64_tr_b16 v[60:61], v17 offset:22528
    ds_read_b64_tr_b16 v[62:63], v17 offset:23552
    v_mfma_f32_32x32x16_bf16 v[176:191], v[36:39], v[212:215], v[176:191]
    v_add_u32 v16, 98304, v12
    v_mfma_f32_32x32x16_bf16 v[176:191], v[40:43], v[216:219], v[176:191]
    v_xor_b32 v17, 0x2000, v16
    v_mfma_f32_32x32x16_bf16 v[176:191], v[44:47], v[220:223], v[176:191]
    s_waitcnt lgkmcnt(0)
    s_barrier
    ds_read_b64_tr_b16 v[32:33], v16 offset:0
    ds_read_b64_tr_b16 v[34:35], v16 offset:1024
    ds_read_b64_tr_b16 v[36:37], v16 offset:2048
    ds_read_b64_tr_b16 v[38:39], v16 offset:3072
    v_mfma_f32_32x32x16_bf16 v[176:191], v[48:51], v[192:195], v[176:191]
    ds_read_b64_tr_b16 v[40:41], v16 offset:4096
    ds_read_b64_tr_b16 v[42:43], v16 offset:5120
    v_mfma_f32_32x32x16_bf16 v[176:191], v[52:55], v[196:199], v[176:191]
    ds_read_b64_tr_b16 v[44:45], v16 offset:6144
    ds_read_b64_tr_b16 v[46:47], v16 offset:7168
    v_mfma_f32_32x32x16_bf16 v[176:191], v[56:59], v[200:203], v[176:191]
    ds_read_b64_tr_b16 v[48:49], v17 offset:0
    ds_read_b64_tr_b16 v[50:51], v17 offset:1024
    v_mfma_f32_32x32x16_bf16 v[176:191], v[60:63], v[204:207], v[176:191]
    ds_read_b64_tr_b16 v[52:53], v17 offset:2048
    ds_read_b64_tr_b16 v[54:55], v17 offset:3072
    s_waitcnt lgkmcnt(4)
    v_mfma_f32_32x32x16_bf16 v[224:239], v[32:35], v[64:67], 0
    ds_read_b64_tr_b16 v[56:57], v17 offset:4096
    ds_read_b64_tr_b16 v[58:59], v17 offset:5120
    v_mfma_f32_32x32x16_bf16 v[224:239], v[36:39], v[68:71], v[224:239]
    ds_read_b64_tr_b16 v[60:61], v17 offset:6144
    ds_read_b64_tr_b16 v[62:63], v17 offset:7168
    v_mfma_f32_32x32x16_bf16 v[224:239], v[40:43], v[72:75], v[224:239]
    ds_read_b64_tr_b16 v[32:33], v16 offset:16384
    ds_read_b64_tr_b16 v[34:35], v16 offset:17408
    ds_read_b64_tr_b16 v[36:37], v16 offset:18432
    ds_read_b64_tr_b16 v[38:39], v16 offset:19456
    v_cvt_pk_bf16_f32 v176, v176, v177
    v_cvt_pk_bf16_f32 v177, v178, v179
    v_cvt_pk_bf16_f32 v178, v180, v181
    v_mfma_f32_32x32x16_bf16 v[224:239], v[44:47], v[76:79], v[224:239]
    ds_read_b64_tr_b16 v[40:41], v16 offset:20480
    ds_read_b64_tr_b16 v[42:43], v16 offset:21504
    v_cvt_pk_bf16_f32 v179, v182, v183
    s_mov_b32 s73, 40960
    s_waitcnt lgkmcnt(6)
    v_mfma_f32_32x32x16_bf16 v[224:239], v[48:51], v[80:83], v[224:239]
    ds_read_b64_tr_b16 v[44:45], v16 offset:22528
    ds_read_b64_tr_b16 v[46:47], v16 offset:23552
    buffer_store_dwordx4 v[176:179], v13, s[60:63], s73 offen offset:0 sc1
    v_cvt_pk_bf16_f32 v180, v184, v185
    v_mfma_f32_32x32x16_bf16 v[224:239], v[52:55], v[84:87], v[224:239]
    ds_read_b64_tr_b16 v[48:49], v17 offset:16384
    ds_read_b64_tr_b16 v[50:51], v17 offset:17408
    v_cvt_pk_bf16_f32 v181, v186, v187
    v_cvt_pk_bf16_f32 v182, v188, v189
    v_mfma_f32_32x32x16_bf16 v[224:239], v[56:59], v[88:91], v[224:239]
    ds_read_b64_tr_b16 v[52:53], v17 offset:18432
    ds_read_b64_tr_b16 v[54:55], v17 offset:19456
    v_cvt_pk_bf16_f32 v183, v190, v191
    buffer_store_dwordx4 v[180:183], v13, s[60:63], s73 offen offset:1024 sc1
    v_mfma_f32_32x32x16_bf16 v[224:239], v[60:63], v[92:95], v[224:239]
    ds_read_b64_tr_b16 v[56:57], v17 offset:20480
    ds_read_b64_tr_b16 v[58:59], v17 offset:21504
    v_lshlrev_b32 v240, 16, v96
    v_and_b32 v241, s30, v96
    v_lshlrev_b32 v242, 16, v97
    s_waitcnt lgkmcnt(6)
    v_mfma_f32_32x32x16_bf16 v[224:239], v[32:35], v[208:211], v[224:239]
    ds_read_b64_tr_b16 v[60:61], v17 offset:22528
    ds_read_b64_tr_b16 v[62:63], v17 offset:23552
    v_and_b32 v243, s30, v97
    v_lshlrev_b32 v244, 16, v98
    v_mfma_f32_32x32x16_bf16 v[224:239], v[36:39], v[212:215], v[224:239]
    v_add_u32 v16, 131072, v12
    v_and_b32 v245, s30, v98
    v_lshlrev_b32 v246, 16, v99
    v_mfma_f32_32x32x16_bf16 v[224:239], v[40:43], v[216:219], v[224:239]
    v_xor_b32 v17, 0x2000, v16
    v_and_b32 v247, s30, v99
    v_lshlrev_b32 v248, 16, v100
    v_and_b32 v249, s30, v100
    v_mfma_f32_32x32x16_bf16 v[224:239], v[44:47], v[220:223], v[224:239]
    s_waitcnt lgkmcnt(0)
    s_barrier
    ds_read_b64_tr_b16 v[32:33], v16 offset:0
    ds_read_b64_tr_b16 v[34:35], v16 offset:1024
    ds_read_b64_tr_b16 v[36:37], v16 offset:2048
    ds_read_b64_tr_b16 v[38:39], v16 offset:3072
    v_lshlrev_b32 v250, 16, v101
    v_and_b32 v251, s30, v101
    v_mfma_f32_32x32x16_bf16 v[224:239], v[48:51], v[192:195], v[224:239]
    ds_read_b64_tr_b16 v[40:41], v16 offset:4096
    ds_read_b64_tr_b16 v[42:43], v16 offset:5120
    v_lshlrev_b32 v252, 16, v102
    v_and_b32 v253, s30, v102
    v_mfma_f32_32x32x16_bf16 v[224:239], v[52:55], v[196:199], v[224:239]
    ds_read_b64_tr_b16 v[44:45], v16 offset:6144
    ds_read_b64_tr_b16 v[46:47], v16 offset:7168
    v_lshlrev_b32 v254, 16, v103
    v_and_b32 v255, s30, v103
    v_mfma_f32_32x32x16_bf16 v[224:239], v[56:59], v[200:203], v[224:239]
    ds_read_b64_tr_b16 v[48:49], v17 offset:0
    ds_read_b64_tr_b16 v[50:51], v17 offset:1024
    v_mfma_f32_32x32x16_bf16 v[224:239], v[60:63], v[204:207], v[224:239]
    ds_read_b64_tr_b16 v[52:53], v17 offset:2048
    ds_read_b64_tr_b16 v[54:55], v17 offset:3072
    v_lshlrev_b32 v160, 16, v104
    v_and_b32 v161, s30, v104
    v_lshlrev_b32 v162, 16, v105
    s_waitcnt lgkmcnt(4)
    v_mfma_f32_32x32x16_bf16 v[240:255], v[32:35], v[208:211], v[240:255]
    ds_read_b64_tr_b16 v[56:57], v17 offset:4096
    ds_read_b64_tr_b16 v[58:59], v17 offset:5120
    v_and_b32 v163, s30, v105
    v_lshlrev_b32 v164, 16, v106
    v_mfma_f32_32x32x16_bf16 v[240:255], v[36:39], v[212:215], v[240:255]
    ds_read_b64_tr_b16 v[60:61], v17 offset:6144
    ds_read_b64_tr_b16 v[62:63], v17 offset:7168
    v_and_b32 v165, s30, v106
    v_lshlrev_b32 v166, 16, v107
    v_mfma_f32_32x32x16_bf16 v[240:255], v[40:43], v[216:219], v[240:255]
    ds_read_b64_tr_b16 v[32:33], v16 offset:16384
    ds_read_b64_tr_b16 v[34:35], v16 offset:17408
    ds_read_b64_tr_b16 v[36:37], v16 offset:18432
    ds_read_b64_tr_b16 v[38:39], v16 offset:19456
    v_cvt_pk_bf16_f32 v224, v224, v225
    v_cvt_pk_bf16_f32 v225, v226, v227
    v_cvt_pk_bf16_f32 v226, v228, v229
    v_and_b32 v167, s30, v107
    v_lshlrev_b32 v168, 16, v108
    v_and_b32 v169, s30, v108
    v_mfma_f32_32x32x16_bf16 v[240:255], v[44:47], v[220:223], v[240:255]
    ds_read_b64_tr_b16 v[40:41], v16 offset:20480
    ds_read_b64_tr_b16 v[42:43], v16 offset:21504
    v_cvt_pk_bf16_f32 v227, v230, v231
    s_mov_b32 s73, 49152
    v_lshlrev_b32 v170, 16, v109
    v_and_b32 v171, s30, v109
    s_waitcnt lgkmcnt(6)
    v_mfma_f32_32x32x16_bf16 v[240:255], v[48:51], v[192:195], v[240:255]
    ds_read_b64_tr_b16 v[44:45], v16 offset:22528
    ds_read_b64_tr_b16 v[46:47], v16 offset:23552
    buffer_store_dwordx4 v[224:227], v13, s[60:63], s73 offen offset:0 sc1
    v_cvt_pk_bf16_f32 v228, v232, v233
    v_lshlrev_b32 v172, 16, v110
    v_and_b32 v173, s30, v110
    v_mfma_f32_32x32x16_bf16 v[240:255], v[52:55], v[196:199], v[240:255]
    ds_read_b64_tr_b16 v[48:49], v17 offset:16384
    ds_read_b64_tr_b16 v[50:51], v17 offset:17408
    v_cvt_pk_bf16_f32 v229, v234, v235
    v_cvt_pk_bf16_f32 v230, v236, v237
    v_lshlrev_b32 v174, 16, v111
    v_and_b32 v175, s30, v111
    v_mfma_f32_32x32x16_bf16 v[240:255], v[56:59], v[200:203], v[240:255]
    ds_read_b64_tr_b16 v[52:53], v17 offset:18432
    ds_read_b64_tr_b16 v[54:55], v17 offset:19456
    v_cvt_pk_bf16_f32 v231, v238, v239
    buffer_store_dwordx4 v[228:231], v13, s[60:63], s73 offen offset:1024 sc1
    v_mfma_f32_32x32x16_bf16 v[240:255], v[60:63], v[204:207], v[240:255]
    ds_read_b64_tr_b16 v[56:57], v17 offset:20480
    ds_read_b64_tr_b16 v[58:59], v17 offset:21504
    s_waitcnt lgkmcnt(6)
    v_mfma_f32_32x32x16_bf16 v[160:175], v[32:35], v[208:211], v[160:175]
    ds_read_b64_tr_b16 v[60:61], v17 offset:22528
    ds_read_b64_tr_b16 v[62:63], v17 offset:23552
    v_mfma_f32_32x32x16_bf16 v[160:175], v[36:39], v[212:215], v[160:175]
    v_mfma_f32_32x32x16_bf16 v[160:175], v[40:43], v[216:219], v[160:175]
    s_nop 3
    v_cvt_pk_bf16_f32 v96, v240, v241
    v_cvt_pk_bf16_f32 v97, v242, v243
    v_cvt_pk_bf16_f32 v98, v244, v245
    v_mov_b32 v24, 5
    s_mov_b64 exec, 1
    s_waitcnt vmcnt(4)
    global_store_dword v0, v24, s[28:29] sc1
    s_mov_b64 exec, -1
    v_mfma_f32_32x32x16_bf16 v[160:175], v[44:47], v[220:223], v[160:175]
    v_cvt_pk_bf16_f32 v99, v246, v247
    s_mov_b32 s73, 57344
    s_waitcnt lgkmcnt(0)
    v_mfma_f32_32x32x16_bf16 v[160:175], v[48:51], v[192:195], v[160:175]
    buffer_store_dwordx4 v[96:99], v13, s[60:63], s73 offen offset:0 sc1
    v_cvt_pk_bf16_f32 v100, v248, v249
    v_mfma_f32_32x32x16_bf16 v[160:175], v[52:55], v[196:199], v[160:175]
    v_cvt_pk_bf16_f32 v101, v250, v251
    v_cvt_pk_bf16_f32 v102, v252, v253
    v_mfma_f32_32x32x16_bf16 v[160:175], v[56:59], v[200:203], v[160:175]
    v_cvt_pk_bf16_f32 v103, v254, v255
    buffer_store_dwordx4 v[100:103], v13, s[60:63], s73 offen offset:1024 sc1
    v_mfma_f32_32x32x16_bf16 v[160:175], v[60:63], v[204:207], v[160:175]
    v_mov_b32 v2, 4
    v_mov_b32 v3, 1
    s_nop 9
    v_cvt_pk_bf16_f32 v104, v160, v161
    v_cvt_pk_bf16_f32 v105, v162, v163
    v_cvt_pk_bf16_f32 v106, v164, v165
    v_cvt_pk_bf16_f32 v107, v166, v167
    s_mov_b32 s73, 65536
    buffer_store_dwordx4 v[104:107], v13, s[60:63], s73 offen offset:0 sc1
    v_cvt_pk_bf16_f32 v108, v168, v169
    v_cvt_pk_bf16_f32 v109, v170, v171
    v_cvt_pk_bf16_f32 v110, v172, v173
    v_cvt_pk_bf16_f32 v111, v174, v175
    buffer_store_dwordx4 v[108:111], v13, s[60:63], s73 offen offset:1024 sc1
    v_mov_b32 v24, 9
    s_mov_b64 exec, 1
    s_waitcnt vmcnt(0)
    global_store_dword v0, v24, s[28:29] sc1
    s_mov_b64 exec, 1
    ds_add_u32 v2, v3
    s_endpgm
L_up1:
    v_mov_b32 v24, v15
    s_nop 1
    v_permlane32_swap_b32 v24, v15
    v_max_f32 v15, v24, v15
    v_sub_f32 v25, v9, v15
    v_exp_f32 v25, v25
    s_mov_b32 s31, 1
    v_mov_b32 v9, v15
    v_sub_f32 v3, 0, v15
    v_and_b32 v24, s30, v3
    v_lshrrev_b32 v2, 16, v3
    v_sub_f32 v3, v3, v24
    v_and_b32 v24, s30, v3
    v_or_b32 v2, v2, v24
    v_sub_f32 v3, v3, v24
    v_lshrrev_b32 v3, 16, v3
    s_nop 1
    s_branch L_upr1
L_up2:
    v_mov_b32 v24, v15
    s_nop 1
    v_permlane32_swap_b32 v24, v15
    v_max_f32 v15, v24, v15
    v_sub_f32 v26, v9, v15
    v_exp_f32 v26, v26
    s_mov_b32 s31, 1
    v_mov_b32 v9, v15
    v_sub_f32 v3, 0, v15
    v_and_b32 v24, s30, v3
    v_lshrrev_b32 v2, 16, v3
    v_sub_f32 v3, v3, v24
    v_and_b32 v24, s30, v3
    v_or_b32 v2, v2, v24
    v_sub_f32 v3, v3, v24
    v_lshrrev_b32 v3, 16, v3
    s_nop 1
    s_branch L_upr2
L_up3:
    v_mov_b32 v24, v15
    s_nop 1
    v_permlane32_swap_b32 v24, v15
    v_max_f32 v15, v24, v15
    v_sub_f32 v27, v9, v15
    v_exp_f32 v27, v27
    s_mov_b32 s31, 1
    v_mov_b32 v9, v15
    v_sub_f32 v3, 0, v15
    v_and_b32 v24, s30, v3
    v_lshrrev_b32 v2, 16, v3
    v_sub_f32 v3, v3, v24
    v_and_b32 v24, s30, v3
    v_or_b32 v2, v2, v24
    v_sub_f32 v3, v3, v24
    v_lshrrev_b32 v3, 16, v3
    s_nop 1
    s_branch L_upr3
L_up4:
    v_mov_b32 v24, v15
    s_nop 1
    v_permlane32_swap_b32 v24, v15
    v_max_f32 v15, v24, v15
    v_sub_f32 v28, v9, v15
    v_exp_f32 v28, v28
    s_mov_b32 s31, 1
    v_mov_b32 v9, v15
    v_sub_f32 v3, 0, v15
    v_and_b32 v24, s30, v3
    v_lshrrev_b32 v2, 16, v3
    v_sub_f32 v3, v3, v24
    v_and_b32 v24, s30, v3
    v_or_b32 v2, v2, v24
    v_sub_f32 v3, v3, v24
    v_lshrrev_b32 v3, 16, v3
    s_nop 1
    s_branch L_upr4
L_up5:
    v_mov_b32 v24, v15
    s_nop 1
    v_permlane32_swap_b32 v24, v15
    v_max_f32 v15, v24, v15
    v_sub_f32 v29, v9, v15
    v_exp_f32 v29, v29
    s_mov_b32 s31, 1
    v_mov_b32 v9, v15
    v_sub_f32 v3, 0, v15
    v_and_b32 v24, s30, v3
    v_lshrrev_b32 v2, 16, v3
    v_sub_f32 v3, v3, v24
    v_and_b32 v24, s30, v3
    v_or_b32 v2, v2, v24
    v_sub_f32 v3, v3, v24
    v_lshrrev_b32 v3, 16, v3
    s_nop 1
    s_branch L_upr5
L_up6:
    v_mov_b32 v24, v15
    s_nop 1
    v_permlane32_swap_b32 v24, v15
    v_max_f32 v15, v24, v15
    v_sub_f32 v30, v9, v15
    v_exp_f32 v30, v30
    s_mov_b32 s31, 1
    v_mov_b32 v9, v15
    v_sub_f32 v3, 0, v15
    v_and_b32 v24, s30, v3
    v_lshrrev_b32 v2, 16, v3
    v_sub_f32 v3, v3, v24
    v_and_b32 v24, s30, v3
    v_or_b32 v2, v2, v24
    v_sub_f32 v3, v3, v24
    v_lshrrev_b32 v3, 16, v3
    s_nop 1
    s_branch L_upr6
L_fix:
    v_mul_f32 v30, v31, v30
    v_mul_f32 v29, v30, v29
    v_mul_f32 v28, v29, v28
    v_mul_f32 v27, v28, v27
    v_mul_f32 v26, v27, v26
    v_mul_f32 v25, v26, v25
    v_mov_b32 v10, 0
    v_mov_b32 v11, 0
    v_lshlrev_b32 v24, 16, v96
    v_and_b32 v1, s30, v96
    v_mul_f32 v24, v25, v24
    v_mul_f32 v1, v25, v1
    v_add_f32 v10, v10, v24
    v_add_f32 v11, v11, v1
    v_cvt_pk_bf16_f32 v96, v24, v1
    v_lshlrev_b32 v24, 16, v97
    v_and_b32 v1, s30, v97
    v_mul_f32 v24, v25, v24
    v_mul_f32 v1, v25, v1
    v_add_f32 v10, v10, v24
    v_add_f32 v11, v11, v1
    v_cvt_pk_bf16_f32 v97, v24, v1
    v_lshlrev_b32 v24, 16, v98
    v_and_b32 v1, s30, v98
    v_mul_f32 v24, v25, v24
    v_mul_f32 v1, v25, v1
    v_add_f32 v10, v10, v24
    v_add_f32 v11, v11, v1
    v_cvt_pk_bf16_f32 v98, v24, v1
    v_lshlrev_b32 v24, 16, v99
    v_and_b32 v1, s30, v99
    v_mul_f32 v24, v25, v24
    v_mul_f32 v1, v25, v1
    v_add_f32 v10, v10, v24
    v_add_f32 v11, v11, v1
    v_cvt_pk_bf16_f32 v99, v24, v1
    v_lshlrev_b32 v24, 16, v100
    v_and_b32 v1, s30, v100
    v_mul_f32 v24, v25, v24
    v_mul_f32 v1, v25, v1
    v_add_f32 v10, v10, v24
    v_add_f32 v11, v11, v1
    v_cvt_pk_bf16_f32 v100, v24, v1
    v_lshlrev_b32 v24, 16, v101
    v_and_b32 v1, s30, v101
    v_mul_f32 v24, v25, v24
    v_mul_f32 v1, v25, v1
    v_add_f32 v10, v10, v24
    v_add_f32 v11, v11, v1
    v_cvt_pk_bf16_f32 v101, v24, v1
    v_lshlrev_b32 v24, 16, v102
    v_and_b32 v1, s30, v102
    v_mul_f32 v24, v25, v24
    v_mul_f32 v1, v25, v1
    v_add_f32 v10, v10, v24
    v_add_f32 v11, v11, v1
    v_cvt_pk_bf16_f32 v102, v24, v1
    v_lshlrev_b32 v24, 16, v103
    v_and_b32 v1, s30, v103
    v_mul_f32 v24, v25, v24
    v_mul_f32 v1, v25, v1
    v_add_f32 v10, v10, v24
    v_add_f32 v11, v11, v1
    v_cvt_pk_bf16_f32 v103, v24, v1
    v_lshlrev_b32 v24, 16, v104
    v_and_b32 v1, s30, v104
    v_mul_f32 v24, v25, v24
    v_mul_f32 v1, v25, v1
    v_add_f32 v10, v10, v24
    v_add_f32 v11, v11, v1
    v_cvt_pk_bf16_f32 v104, v24, v1
    v_lshlrev_b32 v24, 16, v105
    v_and_b32 v1, s30, v105
    v_mul_f32 v24, v25, v24
    v_mul_f32 v1, v25, v1
    v_add_f32 v10, v10, v24
    v_add_f32 v11, v11, v1
    v_cvt_pk_bf16_f32 v105, v24, v1
    v_lshlrev_b32 v24, 16, v106
    v_and_b32 v1, s30, v106
    v_mul_f32 v24, v25, v24
    v_mul_f32 v1, v25, v1
    v_add_f32 v10, v10, v24
    v_add_f32 v11, v11, v1
    v_cvt_pk_bf16_f32 v106, v24, v1
    v_lshlrev_b32 v24, 16, v107
    v_and_b32 v1, s30, v107
    v_mul_f32 v24, v25, v24
    v_mul_f32 v1, v25, v1
    v_add_f32 v10, v10, v24
    v_add_f32 v11, v11, v1
    v_cvt_pk_bf16_f32 v107, v24, v1
    v_lshlrev_b32 v24, 16, v108
    v_and_b32 v1, s30, v108
    v_mul_f32 v24, v25, v24
    v_mul_f32 v1, v25, v1
    v_add_f32 v10, v10, v24
    v_add_f32 v11, v11, v1
    v_cvt_pk_bf16_f32 v108, v24, v1
    v_lshlrev_b32 v24, 16, v109
    v_and_b32 v1, s30, v109
    v_mul_f32 v24, v25, v24
    v_mul_f32 v1, v25, v1
    v_add_f32 v10, v10, v24
    v_add_f32 v11, v11, v1
    v_cvt_pk_bf16_f32 v109, v24, v1
    v_lshlrev_b32 v24, 16, v110
    v_and_b32 v1, s30, v110
    v_mul_f32 v24, v25, v24
    v_mul_f32 v1, v25, v1
    v_add_f32 v10, v10, v24
    v_add_f32 v11, v11, v1
    v_cvt_pk_bf16_f32 v110, v24, v1
    v_lshlrev_b32 v24, 16, v111
    v_and_b32 v1, s30, v111
    v_mul_f32 v24, v25, v24
    v_mul_f32 v1, v25, v1
    v_add_f32 v10, v10, v24
    v_add_f32 v11, v11, v1
    v_cvt_pk_bf16_f32 v111, v24, v1
    v_lshlrev_b32 v24, 16, v112
    v_and_b32 v1, s30, v112
    v_mul_f32 v24, v26, v24
    v_mul_f32 v1, v26, v1
    v_add_f32 v10, v10, v24
    v_add_f32 v11, v11, v1
    v_cvt_pk_bf16_f32 v112, v24, v1
    v_lshlrev_b32 v24, 16, v113
    v_and_b32 v1, s30, v113
    v_mul_f32 v24, v26, v24
    v_mul_f32 v1, v26, v1
    v_add_f32 v10, v10, v24
    v_add_f32 v11, v11, v1
    v_cvt_pk_bf16_f32 v113, v24, v1
    v_lshlrev_b32 v24, 16, v114
    v_and_b32 v1, s30, v114
    v_mul_f32 v24, v26, v24
    v_mul_f32 v1, v26, v1
    v_add_f32 v10, v10, v24
    v_add_f32 v11, v11, v1
    v_cvt_pk_bf16_f32 v114, v24, v1
    v_lshlrev_b32 v24, 16, v115
    v_and_b32 v1, s30, v115
    v_mul_f32 v24, v26, v24
    v_mul_f32 v1, v26, v1
    v_add_f32 v10, v10, v24
    v_add_f32 v11, v11, v1
    v_cvt_pk_bf16_f32 v115, v24, v1
    v_lshlrev_b32 v24, 16, v116
    v_and_b32 v1, s30, v116
    v_mul_f32 v24, v26, v24
    v_mul_f32 v1, v26, v1
    v_add_f32 v10, v10, v24
    v_add_f32 v11, v11, v1
    v_cvt_pk_bf16_f32 v116, v24, v1
    v_lshlrev_b32 v24, 16, v117
    v_and_b32 v1, s30, v117
    v_mul_f32 v24, v26, v24
    v_mul_f32 v1, v26, v1
    v_add_f32 v10, v10, v24
    v_add_f32 v11, v11, v1
    v_cvt_pk_bf16_f32 v117, v24, v1
    v_lshlrev_b32 v24, 16, v118
    v_and_b32 v1, s30, v118
    v_mul_f32 v24, v26, v24
    v_mul_f32 v1, v26, v1
    v_add_f32 v10, v10, v24
    v_add_f32 v11, v11, v1
    v_cvt_pk_bf16_f32 v118, v24, v1
    v_lshlrev_b32 v24, 16, v119
    v_and_b32 v1, s30, v119
    v_mul_f32 v24, v26, v24
    v_mul_f32 v1, v26, v1
    v_add_f32 v10, v10, v24
    v_add_f32 v11, v11, v1
    v_cvt_pk_bf16_f32 v119, v24, v1
    v_lshlrev_b32 v24, 16, v120
    v_and_b32 v1, s30, v120
    v_mul_f32 v24, v26, v24
    v_mul_f32 v1, v26, v1
    v_add_f32 v10, v10, v24
    v_add_f32 v11, v11, v1
    v_cvt_pk_bf16_f32 v120, v24, v1
    v_lshlrev_b32 v24, 16, v121
    v_and_b32 v1, s30, v121
    v_mul_f32 v24, v26, v24
    v_mul_f32 v1, v26, v1
    v_add_f32 v10, v10, v24
    v_add_f32 v11, v11, v1
    v_cvt_pk_bf16_f32 v121, v24, v1
    v_lshlrev_b32 v24, 16, v122
    v_and_b32 v1, s30, v122
    v_mul_f32 v24, v26, v24
    v_mul_f32 v1, v26, v1
    v_add_f32 v10, v10, v24
    v_add_f32 v11, v11, v1
    v_cvt_pk_bf16_f32 v122, v24, v1
    v_lshlrev_b32 v24, 16, v123
    v_and_b32 v1, s30, v123
    v_mul_f32 v24, v26, v24
    v_mul_f32 v1, v26, v1
    v_add_f32 v10, v10, v24
    v_add_f32 v11, v11, v1
    v_cvt_pk_bf16_f32 v123, v24, v1
    v_lshlrev_b32 v24, 16, v124
    v_and_b32 v1, s30, v124
    v_mul_f32 v24, v26, v24
    v_mul_f32 v1, v26, v1
    v_add_f32 v10, v10, v24
    v_add_f32 v11, v11, v1
    v_cvt_pk_bf16_f32 v124, v24, v1
    v_lshlrev_b32 v24, 16, v125
    v_and_b32 v1, s30, v125
    v_mul_f32 v24, v26, v24
    v_mul_f32 v1, v26, v1
    v_add_f32 v10, v10, v24
    v_add_f32 v11, v11, v1
    v_cvt_pk_bf16_f32 v125, v24, v1
    v_lshlrev_b32 v24, 16, v126
    v_and_b32 v1, s30, v126
    v_mul_f32 v24, v26, v24
    v_mul_f32 v1, v26, v1
    v_add_f32 v10, v10, v24
    v_add_f32 v11, v11, v1
    v_cvt_pk_bf16_f32 v126, v24, v1
    v_lshlrev_b32 v24, 16, v127
    v_and_b32 v1, s30, v127
    v_mul_f32 v24, v26, v24
    v_mul_f32 v1, v26, v1
    v_add_f32 v10, v10, v24
    v_add_f32 v11, v11, v1
    v_cvt_pk_bf16_f32 v127, v24, v1
    v_lshlrev_b32 v24, 16, v128
    v_and_b32 v1, s30, v128
    v_mul_f32 v24, v27, v24
    v_mul_f32 v1, v27, v1
    v_add_f32 v10, v10, v24
    v_add_f32 v11, v11, v1
    v_cvt_pk_bf16_f32 v128, v24, v1
    v_lshlrev_b32 v24, 16, v129
    v_and_b32 v1, s30, v129
    v_mul_f32 v24, v27, v24
    v_mul_f32 v1, v27, v1
    v_add_f32 v10, v10, v24
    v_add_f32 v11, v11, v1
    v_cvt_pk_bf16_f32 v129, v24, v1
    v_lshlrev_b32 v24, 16, v130
    v_and_b32 v1, s30, v130
    v_mul_f32 v24, v27, v24
    v_mul_f32 v1, v27, v1
    v_add_f32 v10, v10, v24
    v_add_f32 v11, v11, v1
    v_cvt_pk_bf16_f32 v130, v24, v1
    v_lshlrev_b32 v24, 16, v131
    v_and_b32 v1, s30, v131
    v_mul_f32 v24, v27, v24
    v_mul_f32 v1, v27, v1
    v_add_f32 v10, v10, v24
    v_add_f32 v11, v11, v1
    v_cvt_pk_bf16_f32 v131, v24, v1
    v_lshlrev_b32 v24, 16, v132
    v_and_b32 v1, s30, v132
    v_mul_f32 v24, v27, v24
    v_mul_f32 v1, v27, v1
    v_add_f32 v10, v10, v24
    v_add_f32 v11, v11, v1
    v_cvt_pk_bf16_f32 v132, v24, v1
    v_lshlrev_b32 v24, 16, v133
    v_and_b32 v1, s30, v133
    v_mul_f32 v24, v27, v24
    v_mul_f32 v1, v27, v1
    v_add_f32 v10, v10, v24
    v_add_f32 v11, v11, v1
    v_cvt_pk_bf16_f32 v133, v24, v1
    v_lshlrev_b32 v24, 16, v134
    v_and_b32 v1, s30, v134
    v_mul_f32 v24, v27, v24
    v_mul_f32 v1, v27, v1
    v_add_f32 v10, v10, v24
    v_add_f32 v11, v11, v1
    v_cvt_pk_bf16_f32 v134, v24, v1
    v_lshlrev_b32 v24, 16, v135
    v_and_b32 v1, s30, v135
    v_mul_f32 v24, v27, v24
    v_mul_f32 v1, v27, v1
    v_add_f32 v10, v10, v24
    v_add_f32 v11, v11, v1
    v_cvt_pk_bf16_f32 v135, v24, v1
    v_lshlrev_b32 v24, 16, v136
    v_and_b32 v1, s30, v136
    v_mul_f32 v24, v27, v24
    v_mul_f32 v1, v27, v1
    v_add_f32 v10, v10, v24
    v_add_f32 v11, v11, v1
    v_cvt_pk_bf16_f32 v136, v24, v1
    v_lshlrev_b32 v24, 16, v137
    v_and_b32 v1, s30, v137
    v_mul_f32 v24, v27, v24
    v_mul_f32 v1, v27, v1
    v_add_f32 v10, v10, v24
    v_add_f32 v11, v11, v1
    v_cvt_pk_bf16_f32 v137, v24, v1
    v_lshlrev_b32 v24, 16, v138
    v_and_b32 v1, s30, v138
    v_mul_f32 v24, v27, v24
    v_mul_f32 v1, v27, v1
    v_add_f32 v10, v10, v24
    v_add_f32 v11, v11, v1
    v_cvt_pk_bf16_f32 v138, v24, v1
    v_lshlrev_b32 v24, 16, v139
    v_and_b32 v1, s30, v139
    v_mul_f32 v24, v27, v24
    v_mul_f32 v1, v27, v1
    v_add_f32 v10, v10, v24
    v_add_f32 v11, v11, v1
    v_cvt_pk_bf16_f32 v139, v24, v1
    v_lshlrev_b32 v24, 16, v140
    v_and_b32 v1, s30, v140
    v_mul_f32 v24, v27, v24
    v_mul_f32 v1, v27, v1
    v_add_f32 v10, v10, v24
    v_add_f32 v11, v11, v1
    v_cvt_pk_bf16_f32 v140, v24, v1
    v_lshlrev_b32 v24, 16, v141
    v_and_b32 v1, s30, v141
    v_mul_f32 v24, v27, v24
    v_mul_f32 v1, v27, v1
    v_add_f32 v10, v10, v24
    v_add_f32 v11, v11, v1
    v_cvt_pk_bf16_f32 v141, v24, v1
    v_lshlrev_b32 v24, 16, v142
    v_and_b32 v1, s30, v142
    v_mul_f32 v24, v27, v24
    v_mul_f32 v1, v27, v1
    v_add_f32 v10, v10, v24
    v_add_f32 v11, v11, v1
    v_cvt_pk_bf16_f32 v142, v24, v1
    v_lshlrev_b32 v24, 16, v143
    v_and_b32 v1, s30, v143
    v_mul_f32 v24, v27, v24
    v_mul_f32 v1, v27, v1
    v_add_f32 v10, v10, v24
    v_add_f32 v11, v11, v1
    v_cvt_pk_bf16_f32 v143, v24, v1
    v_lshlrev_b32 v24, 16, v144
    v_and_b32 v1, s30, v144
    v_mul_f32 v24, v28, v24
    v_mul_f32 v1, v28, v1
    v_add_f32 v10, v10, v24
    v_add_f32 v11, v11, v1
    v_cvt_pk_bf16_f32 v144, v24, v1
    v_lshlrev_b32 v24, 16, v145
    v_and_b32 v1, s30, v145
    v_mul_f32 v24, v28, v24
    v_mul_f32 v1, v28, v1
    v_add_f32 v10, v10, v24
    v_add_f32 v11, v11, v1
    v_cvt_pk_bf16_f32 v145, v24, v1
    v_lshlrev_b32 v24, 16, v146
    v_and_b32 v1, s30, v146
    v_mul_f32 v24, v28, v24
    v_mul_f32 v1, v28, v1
    v_add_f32 v10, v10, v24
    v_add_f32 v11, v11, v1
    v_cvt_pk_bf16_f32 v146, v24, v1
    v_lshlrev_b32 v24, 16, v147
    v_and_b32 v1, s30, v147
    v_mul_f32 v24, v28, v24
    v_mul_f32 v1, v28, v1
    v_add_f32 v10, v10, v24
    v_add_f32 v11, v11, v1
    v_cvt_pk_bf16_f32 v147, v24, v1
    v_lshlrev_b32 v24, 16, v148
    v_and_b32 v1, s30, v148
    v_mul_f32 v24, v28, v24
    v_mul_f32 v1, v28, v1
    v_add_f32 v10, v10, v24
    v_add_f32 v11, v11, v1
    v_cvt_pk_bf16_f32 v148, v24, v1
    v_lshlrev_b32 v24, 16, v149
    v_and_b32 v1, s30, v149
    v_mul_f32 v24, v28, v24
    v_mul_f32 v1, v28, v1
    v_add_f32 v10, v10, v24
    v_add_f32 v11, v11, v1
    v_cvt_pk_bf16_f32 v149, v24, v1
    v_lshlrev_b32 v24, 16, v150
    v_and_b32 v1, s30, v150
    v_mul_f32 v24, v28, v24
    v_mul_f32 v1, v28, v1
    v_add_f32 v10, v10, v24
    v_add_f32 v11, v11, v1
    v_cvt_pk_bf16_f32 v150, v24, v1
    v_lshlrev_b32 v24, 16, v151
    v_and_b32 v1, s30, v151
    v_mul_f32 v24, v28, v24
    v_mul_f32 v1, v28, v1
    v_add_f32 v10, v10, v24
    v_add_f32 v11, v11, v1
    v_cvt_pk_bf16_f32 v151, v24, v1
    v_lshlrev_b32 v24, 16, v152
    v_and_b32 v1, s30, v152
    v_mul_f32 v24, v28, v24
    v_mul_f32 v1, v28, v1
    v_add_f32 v10, v10, v24
    v_add_f32 v11, v11, v1
    v_cvt_pk_bf16_f32 v152, v24, v1
    v_lshlrev_b32 v24, 16, v153
    v_and_b32 v1, s30, v153
    v_mul_f32 v24, v28, v24
    v_mul_f32 v1, v28, v1
    v_add_f32 v10, v10, v24
    v_add_f32 v11, v11, v1
    v_cvt_pk_bf16_f32 v153, v24, v1
    v_lshlrev_b32 v24, 16, v154
    v_and_b32 v1, s30, v154
    v_mul_f32 v24, v28, v24
    v_mul_f32 v1, v28, v1
    v_add_f32 v10, v10, v24
    v_add_f32 v11, v11, v1
    v_cvt_pk_bf16_f32 v154, v24, v1
    v_lshlrev_b32 v24, 16, v155
    v_and_b32 v1, s30, v155
    v_mul_f32 v24, v28, v24
    v_mul_f32 v1, v28, v1
    v_add_f32 v10, v10, v24
    v_add_f32 v11, v11, v1
    v_cvt_pk_bf16_f32 v155, v24, v1
    v_lshlrev_b32 v24, 16, v156
    v_and_b32 v1, s30, v156
    v_mul_f32 v24, v28, v24
    v_mul_f32 v1, v28, v1
    v_add_f32 v10, v10, v24
    v_add_f32 v11, v11, v1
    v_cvt_pk_bf16_f32 v156, v24, v1
    v_lshlrev_b32 v24, 16, v157
    v_and_b32 v1, s30, v157
    v_mul_f32 v24, v28, v24
    v_mul_f32 v1, v28, v1
    v_add_f32 v10, v10, v24
    v_add_f32 v11, v11, v1
    v_cvt_pk_bf16_f32 v157, v24, v1
    v_lshlrev_b32 v24, 16, v158
    v_and_b32 v1, s30, v158
    v_mul_f32 v24, v28, v24
    v_mul_f32 v1, v28, v1
    v_add_f32 v10, v10, v24
    v_add_f32 v11, v11, v1
    v_cvt_pk_bf16_f32 v158, v24, v1
    v_lshlrev_b32 v24, 16, v159
    v_and_b32 v1, s30, v159
    v_mul_f32 v24, v28, v24
    v_mul_f32 v1, v28, v1
    v_add_f32 v10, v10, v24
    v_add_f32 v11, v11, v1
    v_cvt_pk_bf16_f32 v159, v24, v1
    v_lshlrev_b32 v24, 16, v160
    v_and_b32 v1, s30, v160
    v_mul_f32 v24, v29, v24
    v_mul_f32 v1, v29, v1
    v_add_f32 v10, v10, v24
    v_add_f32 v11, v11, v1
    v_cvt_pk_bf16_f32 v160, v24, v1
    v_lshlrev_b32 v24, 16, v161
    v_and_b32 v1, s30, v161
    v_mul_f32 v24, v29, v24
    v_mul_f32 v1, v29, v1
    v_add_f32 v10, v10, v24
    v_add_f32 v11, v11, v1
    v_cvt_pk_bf16_f32 v161, v24, v1
    v_lshlrev_b32 v24, 16, v162
    v_and_b32 v1, s30, v162
    v_mul_f32 v24, v29, v24
    v_mul_f32 v1, v29, v1
    v_add_f32 v10, v10, v24
    v_add_f32 v11, v11, v1
    v_cvt_pk_bf16_f32 v162, v24, v1
    v_lshlrev_b32 v24, 16, v163
    v_and_b32 v1, s30, v163
    v_mul_f32 v24, v29, v24
    v_mul_f32 v1, v29, v1
    v_add_f32 v10, v10, v24
    v_add_f32 v11, v11, v1
    v_cvt_pk_bf16_f32 v163, v24, v1
    v_lshlrev_b32 v24, 16, v164
    v_and_b32 v1, s30, v164
    v_mul_f32 v24, v29, v24
    v_mul_f32 v1, v29, v1
    v_add_f32 v10, v10, v24
    v_add_f32 v11, v11, v1
    v_cvt_pk_bf16_f32 v164, v24, v1
    v_lshlrev_b32 v24, 16, v165
    v_and_b32 v1, s30, v165
    v_mul_f32 v24, v29, v24
    v_mul_f32 v1, v29, v1
    v_add_f32 v10, v10, v24
    v_add_f32 v11, v11, v1
    v_cvt_pk_bf16_f32 v165, v24, v1
    v_lshlrev_b32 v24, 16, v166
    v_and_b32 v1, s30, v166
    v_mul_f32 v24, v29, v24
    v_mul_f32 v1, v29, v1
    v_add_f32 v10, v10, v24
    v_add_f32 v11, v11, v1
    v_cvt_pk_bf16_f32 v166, v24, v1
    v_lshlrev_b32 v24, 16, v167
    v_and_b32 v1, s30, v167
    v_mul_f32 v24, v29, v24
    v_mul_f32 v1, v29, v1
    v_add_f32 v10, v10, v24
    v_add_f32 v11, v11, v1
    v_cvt_pk_bf16_f32 v167, v24, v1
    v_lshlrev_b32 v24, 16, v168
    v_and_b32 v1, s30, v168
    v_mul_f32 v24, v29, v24
    v_mul_f32 v1, v29, v1
    v_add_f32 v10, v10, v24
    v_add_f32 v11, v11, v1
    v_cvt_pk_bf16_f32 v168, v24, v1
    v_lshlrev_b32 v24, 16, v169
    v_and_b32 v1, s30, v169
    v_mul_f32 v24, v29, v24
    v_mul_f32 v1, v29, v1
    v_add_f32 v10, v10, v24
    v_add_f32 v11, v11, v1
    v_cvt_pk_bf16_f32 v169, v24, v1
    v_lshlrev_b32 v24, 16, v170
    v_and_b32 v1, s30, v170
    v_mul_f32 v24, v29, v24
    v_mul_f32 v1, v29, v1
    v_add_f32 v10, v10, v24
    v_add_f32 v11, v11, v1
    v_cvt_pk_bf16_f32 v170, v24, v1
    v_lshlrev_b32 v24, 16, v171
    v_and_b32 v1, s30, v171
    v_mul_f32 v24, v29, v24
    v_mul_f32 v1, v29, v1
    v_add_f32 v10, v10, v24
    v_add_f32 v11, v11, v1
    v_cvt_pk_bf16_f32 v171, v24, v1
    v_lshlrev_b32 v24, 16, v172
    v_and_b32 v1, s30, v172
    v_mul_f32 v24, v29, v24
    v_mul_f32 v1, v29, v1
    v_add_f32 v10, v10, v24
    v_add_f32 v11, v11, v1
    v_cvt_pk_bf16_f32 v172, v24, v1
    v_lshlrev_b32 v24, 16, v173
    v_and_b32 v1, s30, v173
    v_mul_f32 v24, v29, v24
    v_mul_f32 v1, v29, v1
    v_add_f32 v10, v10, v24
    v_add_f32 v11, v11, v1
    v_cvt_pk_bf16_f32 v173, v24, v1
    v_lshlrev_b32 v24, 16, v174
    v_and_b32 v1, s30, v174
    v_mul_f32 v24, v29, v24
    v_mul_f32 v1, v29, v1
    v_add_f32 v10, v10, v24
    v_add_f32 v11, v11, v1
    v_cvt_pk_bf16_f32 v174, v24, v1
    v_lshlrev_b32 v24, 16, v175
    v_and_b32 v1, s30, v175
    v_mul_f32 v24, v29, v24
    v_mul_f32 v1, v29, v1
    v_add_f32 v10, v10, v24
    v_add_f32 v11, v11, v1
    v_cvt_pk_bf16_f32 v175, v24, v1
    v_lshlrev_b32 v24, 16, v176
    v_and_b32 v1, s30, v176
    v_mul_f32 v24, v30, v24
    v_mul_f32 v1, v30, v1
    v_add_f32 v10, v10, v24
    v_add_f32 v11, v11, v1
    v_cvt_pk_bf16_f32 v176, v24, v1
    v_lshlrev_b32 v24, 16, v177
    v_and_b32 v1, s30, v177
    v_mul_f32 v24, v30, v24
    v_mul_f32 v1, v30, v1
    v_add_f32 v10, v10, v24
    v_add_f32 v11, v11, v1
    v_cvt_pk_bf16_f32 v177, v24, v1
    v_lshlrev_b32 v24, 16, v178
    v_and_b32 v1, s30, v178
    v_mul_f32 v24, v30, v24
    v_mul_f32 v1, v30, v1
    v_add_f32 v10, v10, v24
    v_add_f32 v11, v11, v1
    v_cvt_pk_bf16_f32 v178, v24, v1
    v_lshlrev_b32 v24, 16, v179
    v_and_b32 v1, s30, v179
    v_mul_f32 v24, v30, v24
    v_mul_f32 v1, v30, v1
    v_add_f32 v10, v10, v24
    v_add_f32 v11, v11, v1
    v_cvt_pk_bf16_f32 v179, v24, v1
    v_lshlrev_b32 v24, 16, v180
    v_and_b32 v1, s30, v180
    v_mul_f32 v24, v30, v24
    v_mul_f32 v1, v30, v1
    v_add_f32 v10, v10, v24
    v_add_f32 v11, v11, v1
    v_cvt_pk_bf16_f32 v180, v24, v1
    v_lshlrev_b32 v24, 16, v181
    v_and_b32 v1, s30, v181
    v_mul_f32 v24, v30, v24
    v_mul_f32 v1, v30, v1
    v_add_f32 v10, v10, v24
    v_add_f32 v11, v11, v1
    v_cvt_pk_bf16_f32 v181, v24, v1
    v_lshlrev_b32 v24, 16, v182
    v_and_b32 v1, s30, v182
    v_mul_f32 v24, v30, v24
    v_mul_f32 v1, v30, v1
    v_add_f32 v10, v10, v24
    v_add_f32 v11, v11, v1
    v_cvt_pk_bf16_f32 v182, v24, v1
    v_lshlrev_b32 v24, 16, v183
    v_and_b32 v1, s30, v183
    v_mul_f32 v24, v30, v24
    v_mul_f32 v1, v30, v1
    v_add_f32 v10, v10, v24
    v_add_f32 v11, v11, v1
    v_cvt_pk_bf16_f32 v183, v24, v1
    v_lshlrev_b32 v24, 16, v184
    v_and_b32 v1, s30, v184
    v_mul_f32 v24, v30, v24
    v_mul_f32 v1, v30, v1
    v_add_f32 v10, v10, v24
    v_add_f32 v11, v11, v1
    v_cvt_pk_bf16_f32 v184, v24, v1
    v_lshlrev_b32 v24, 16, v185
    v_and_b32 v1, s30, v185
    v_mul_f32 v24, v30, v24
    v_mul_f32 v1, v30, v1
    v_add_f32 v10, v10, v24
    v_add_f32 v11, v11, v1
    v_cvt_pk_bf16_f32 v185, v24, v1
    v_lshlrev_b32 v24, 16, v186
    v_and_b32 v1, s30, v186
    v_mul_f32 v24, v30, v24
    v_mul_f32 v1, v30, v1
    v_add_f32 v10, v10, v24
    v_add_f32 v11, v11, v1
    v_cvt_pk_bf16_f32 v186, v24, v1
    v_lshlrev_b32 v24, 16, v187
    v_and_b32 v1, s30, v187
    v_mul_f32 v24, v30, v24
    v_mul_f32 v1, v30, v1
    v_add_f32 v10, v10, v24
    v_add_f32 v11, v11, v1
    v_cvt_pk_bf16_f32 v187, v24, v1
    v_lshlrev_b32 v24, 16, v188
    v_and_b32 v1, s30, v188
    v_mul_f32 v24, v30, v24
    v_mul_f32 v1, v30, v1
    v_add_f32 v10, v10, v24
    v_add_f32 v11, v11, v1
    v_cvt_pk_bf16_f32 v188, v24, v1
    v_lshlrev_b32 v24, 16, v189
    v_and_b32 v1, s30, v189
    v_mul_f32 v24, v30, v24
    v_mul_f32 v1, v30, v1
    v_add_f32 v10, v10, v24
    v_add_f32 v11, v11, v1
    v_cvt_pk_bf16_f32 v189, v24, v1
    v_lshlrev_b32 v24, 16, v190
    v_and_b32 v1, s30, v190
    v_mul_f32 v24, v30, v24
    v_mul_f32 v1, v30, v1
    v_add_f32 v10, v10, v24
    v_add_f32 v11, v11, v1
    v_cvt_pk_bf16_f32 v190, v24, v1
    v_lshlrev_b32 v24, 16, v191
    v_and_b32 v1, s30, v191
    v_mul_f32 v24, v30, v24
    v_mul_f32 v1, v30, v1
    v_add_f32 v10, v10, v24
    v_add_f32 v11, v11, v1
    v_cvt_pk_bf16_f32 v191, v24, v1
    v_lshlrev_b32 v24, 16, v192
    v_and_b32 v1, s30, v192
    v_mul_f32 v24, v31, v24
    v_mul_f32 v1, v31, v1
    v_add_f32 v10, v10, v24
    v_add_f32 v11, v11, v1
    v_cvt_pk_bf16_f32 v192, v24, v1
    v_lshlrev_b32 v24, 16, v193
    v_and_b32 v1, s30, v193
    v_mul_f32 v24, v31, v24
    v_mul_f32 v1, v31, v1
    v_add_f32 v10, v10, v24
    v_add_f32 v11, v11, v1
    v_cvt_pk_bf16_f32 v193, v24, v1
    v_lshlrev_b32 v24, 16, v194
    v_and_b32 v1, s30, v194
    v_mul_f32 v24, v31, v24
    v_mul_f32 v1, v31, v1
    v_add_f32 v10, v10, v24
    v_add_f32 v11, v11, v1
    v_cvt_pk_bf16_f32 v194, v24, v1
    v_lshlrev_b32 v24, 16, v195
    v_and_b32 v1, s30, v195
    v_mul_f32 v24, v31, v24
    v_mul_f32 v1, v31, v1
    v_add_f32 v10, v10, v24
    v_add_f32 v11, v11, v1
    v_cvt_pk_bf16_f32 v195, v24, v1
    v_lshlrev_b32 v24, 16, v196
    v_and_b32 v1, s30, v196
    v_mul_f32 v24, v31, v24
    v_mul_f32 v1, v31, v1
    v_add_f32 v10, v10, v24
    v_add_f32 v11, v11, v1
    v_cvt_pk_bf16_f32 v196, v24, v1
    v_lshlrev_b32 v24, 16, v197
    v_and_b32 v1, s30, v197
    v_mul_f32 v24, v31, v24
    v_mul_f32 v1, v31, v1
    v_add_f32 v10, v10, v24
    v_add_f32 v11, v11, v1
    v_cvt_pk_bf16_f32 v197, v24, v1
    v_lshlrev_b32 v24, 16, v198
    v_and_b32 v1, s30, v198
    v_mul_f32 v24, v31, v24
    v_mul_f32 v1, v31, v1
    v_add_f32 v10, v10, v24
    v_add_f32 v11, v11, v1
    v_cvt_pk_bf16_f32 v198, v24, v1
    v_lshlrev_b32 v24, 16, v199
    v_and_b32 v1, s30, v199
    v_mul_f32 v24, v31, v24
    v_mul_f32 v1, v31, v1
    v_add_f32 v10, v10, v24
    v_add_f32 v11, v11, v1
    v_cvt_pk_bf16_f32 v199, v24, v1
    v_lshlrev_b32 v24, 16, v200
    v_and_b32 v1, s30, v200
    v_mul_f32 v24, v31, v24
    v_mul_f32 v1, v31, v1
    v_add_f32 v10, v10, v24
    v_add_f32 v11, v11, v1
    v_cvt_pk_bf16_f32 v200, v24, v1
    v_lshlrev_b32 v24, 16, v201
    v_and_b32 v1, s30, v201
    v_mul_f32 v24, v31, v24
    v_mul_f32 v1, v31, v1
    v_add_f32 v10, v10, v24
    v_add_f32 v11, v11, v1
    v_cvt_pk_bf16_f32 v201, v24, v1
    v_lshlrev_b32 v24, 16, v202
    v_and_b32 v1, s30, v202
    v_mul_f32 v24, v31, v24
    v_mul_f32 v1, v31, v1
    v_add_f32 v10, v10, v24
    v_add_f32 v11, v11, v1
    v_cvt_pk_bf16_f32 v202, v24, v1
    v_lshlrev_b32 v24, 16, v203
    v_and_b32 v1, s30, v203
    v_mul_f32 v24, v31, v24
    v_mul_f32 v1, v31, v1
    v_add_f32 v10, v10, v24
    v_add_f32 v11, v11, v1
    v_cvt_pk_bf16_f32 v203, v24, v1
    v_lshlrev_b32 v24, 16, v204
    v_and_b32 v1, s30, v204
    v_mul_f32 v24, v31, v24
    v_mul_f32 v1, v31, v1
    v_add_f32 v10, v10, v24
    v_add_f32 v11, v11, v1
    v_cvt_pk_bf16_f32 v204, v24, v1
    v_lshlrev_b32 v24, 16, v205
    v_and_b32 v1, s30, v205
    v_mul_f32 v24, v31, v24
    v_mul_f32 v1, v31, v1
    v_add_f32 v10, v10, v24
    v_add_f32 v11, v11, v1
    v_cvt_pk_bf16_f32 v205, v24, v1
    v_lshlrev_b32 v24, 16, v206
    v_and_b32 v1, s30, v206
    v_mul_f32 v24, v31, v24
    v_mul_f32 v1, v31, v1
    v_add_f32 v10, v10, v24
    v_add_f32 v11, v11, v1
    v_cvt_pk_bf16_f32 v206, v24, v1
    v_lshlrev_b32 v24, 16, v207
    v_and_b32 v1, s30, v207
    v_mul_f32 v24, v31, v24
    v_mul_f32 v1, v31, v1
    v_add_f32 v10, v10, v24
    v_add_f32 v11, v11, v1
    v_cvt_pk_bf16_f32 v207, v24, v1
    s_nop 1
    s_branch L_fixr
L_up7:
    v_mov_b32 v24, v15
    s_nop 1
    v_permlane32_swap_b32 v24, v15
    v_max_f32 v15, v24, v15
    v_sub_f32 v31, v9, v15
    v_exp_f32 v31, v31
    s_mov_b32 s31, 1
    v_mov_b32 v9, v15
    v_sub_f32 v3, 0, v15
    v_and_b32 v24, s30, v3
    v_lshrrev_b32 v2, 16, v3
    v_sub_f32 v3, v3, v24
    v_and_b32 v24, s30, v3
    v_or_b32 v2, v2, v24
    v_sub_f32 v3, v3, v24
    v_lshrrev_b32 v3, 16, v3
    s_nop 1
    s_branch L_upr7
L_end:
    s_endpgm
L_codeend:
.section .rodata,"a"
.p2align 6
.amdhsa_kernel concat_heads__gqa_block_cached__mha_block_cached__near_ridge_kernel
  .amdhsa_next_free_vgpr 256
  .amdhsa_next_free_sgpr 102
  .amdhsa_accum_offset 256
  .amdhsa_group_segment_fixed_size 0
  .amdhsa_kernarg_size 104
  .amdhsa_user_sgpr_count 2
  .amdhsa_user_sgpr_kernarg_segment_ptr 1
  .amdhsa_system_sgpr_workgroup_id_x 1
.end_amdhsa_kernel
```
